```python
import torch

def _softmax(x, axis=-1):
    return torch.softmax(x, dim=axis)
def _gelu(x):
    return torch.nn.functional.gelu(x, approximate="tanh")
def _silu(x):
    return torch.nn.functional.silu(x)
def _sigmoid(x):
    return torch.sigmoid(x)
def _layernorm(x, axis=-1, eps=1e-5):
    m = x.mean(dim=axis, keepdim=True)
    v = x.var(dim=axis, keepdim=True, unbiased=False)
    return (x - m) / torch.sqrt(v + eps)
def _scatter_add(tgt, idx, src, axis=0):
    return tgt.clone().index_add_(axis, idx, src)
def _segment_sum(src, seg, n):
    out = torch.zeros((n,) + src.shape[1:], dtype=src.dtype)
    return out.index_add_(0, seg, src)
def _pad(x, pw):
    flat = tuple(v for pair in reversed(pw) for v in pair)
    return torch.nn.functional.pad(x, flat)

kernel_name = 'sequential_preLN__mha_block_cached__dense_activation_silu__decode'

def setup_inputs():

    _w = (lambda a: (lambda t: t.to(torch.bfloat16) if t.is_floating_point() else t)(torch.as_tensor(a)))
    def _A_setup():
        B, Sq, D = 4, 1, 448
        H, Sk, Dh = 16, 8192, 256
        return {
            "x": _w((lambda *s: torch.randn(*s, dtype=torch.bfloat16) * 0.05)(B, Sq, D)),
            "k_cache": _w((lambda *s: torch.randn(*s, dtype=torch.bfloat16) * 3.2)(B, H, Sk, Dh)),
            "v_cache": _w((lambda *s: torch.randn(*s, dtype=torch.bfloat16) * 0.8)(B, H, Sk, Dh)),
            "wq": _w((lambda *s: torch.randn(*s, dtype=torch.bfloat16) * 3.2)(D, H * Dh) * (D ** -0.5)),
            "wo": _w((lambda *s: torch.randn(*s, dtype=torch.bfloat16) * 0.8)(H * Dh, D) * ((H * Dh) ** -0.5)),
        }
    _A_in = _A_setup()

    def _B_setup():
        B, S, D, F = 4, 1, 448, 1792
        return {
            "x": _w((lambda *s: torch.randn(*s, dtype=torch.bfloat16) * 0.05)(B, S, D)),
            "w1": _w((lambda *s: torch.randn(*s, dtype=torch.bfloat16) * 3.2)(D, F) * (D ** -0.5)),
            "w2": _w((lambda *s: torch.randn(*s, dtype=torch.bfloat16) * 0.8)(F, D) * (F ** -0.5)),
        }
    _B_in = _B_setup()

    return {
        "A_x": _A_in["x"],
        "A_k_cache": _A_in["k_cache"],
        "A_v_cache": _A_in["v_cache"],
        "A_wq": _A_in["wq"],
        "A_wo": _A_in["wo"],
        "B_x": _B_in["x"],
        "B_w1": _B_in["w1"],
        "B_w2": _B_in["w2"],
    }

def reference(A_x, A_k_cache, A_v_cache, A_wq, A_wo, B_x, B_w1, B_w2):
    def _A_ref(x, k_cache, v_cache, wq, wo):
        B, Sq, D = x.shape
        H, Dh = 16, 256
        q = (lambda x, *d: x.permute(*d))((x @ wq).reshape(B, Sq, H, Dh), 0, 2, 1, 3)
        scores = torch.einsum("bhqd,bhkd->bhqk", q, k_cache) * (Dh ** -0.5)
        p = _softmax(scores, axis=-1)
        o = torch.einsum("bhqk,bhkd->bhqd", p, v_cache)
        return (lambda x, *d: x.permute(*d))(o, 0, 2, 1, 3).reshape(B, Sq, H * Dh) @ wo

    def _B_ref(x, w1, w2):
        h = torch.einsum("bsd,df->bsf", x, w1)
        h = _silu(h)
        out = torch.einsum("bsf,fd->bsd", h, w2)
        return out

    x = A_x
    h = x + _A_ref(_layernorm(x, axis=-1), A_k_cache, A_v_cache, A_wq, A_wo)
    h2 = h + _B_ref(_layernorm(h, axis=-1), B_w1, B_w2)
    return h2
```

```asm
; @launch grid=(256,1,1) block=(256,1,1) lds=139904
.amdgcn_target "amdgcn-amd-amdhsa--gfx950"
.text
.globl sequential_preLN__mha_block_cached__dense_activation_silu__decode_kernel
.p2align 8
.type sequential_preLN__mha_block_cached__dense_activation_silu__decode_kernel,@function
sequential_preLN__mha_block_cached__dense_activation_silu__decode_kernel:
  s_cmp_ge_u32 s2, 256
  s_cbranch_scc1 A_end
  s_load_dwordx8 s[4:11], s[0:1], 0
  s_load_dwordx2 s[32:33], s[0:1], 80
  v_lshrrev_b32 v7, 6, v0
  v_and_b32 v1, 63, v0
  v_readfirstlane_b32 s3, v7
  v_and_b32 v2, 15, v1
  v_lshrrev_b32 v3, 4, v1
  s_and_b32 s34, s2, 7
  s_lshr_b32 s35, s2, 3
  s_and_b32 s36, s35, 1
  s_lshl_b32 s34, s34, 1
  s_add_u32 s34, s34, s36
  s_lshr_b32 s35, s35, 1
  s_lshr_b32 s36, s35, 2
  s_and_b32 s35, s35, 3
  s_lshl_b32 s37, s36, 4
  s_add_u32 s37, s37, s34
  s_lshl_b32 s37, s37, 2
  s_add_u32 s37, s37, s35
  s_and_b32 s39, s3, 1
  s_lshl_b32 s70, s37, 20
  s_lshr_b32 s38, s2, 0
  s_mul_i32 s38, s38, 32
  s_and_b32 s38, s38, 127
  s_lshl_b32 s38, s38, 13
  s_add_u32 s71, s38, 0x100000
  s_lshl_b32 s44, s39, 13
  s_add_u32 s38, s38, s44
  v_lshlrev_b32 v4, 9, v2
  v_lshl_add_u32 v4, v3, 4, v4
  v_lshlrev_b32 v5, 11, v3
  v_lshl_add_u32 v5, v2, 4, v5
  s_mov_b32 s45, 0x3db8aa3b
  s_waitcnt lgkmcnt(0)
  s_mov_b32 s16, s6
  s_mov_b32 s17, s7
  s_mov_b32 s18, 0x10000000
  s_mov_b32 s19, 0x00020000
  s_mov_b32 s20, s8
  s_mov_b32 s21, s9
  s_mov_b32 s22, 0x10000000
  s_mov_b32 s23, 0x00020000
  s_add_u32 s18, s37, 1
  s_lshl_b32 s18, s18, 20
  s_mov_b32 s22, s18
  s_cmp_ge_u32 s3, 2
  s_cbranch_scc1 A_helper
  s_lshl_b32 s46, s39, 14
  s_mov_b32 s47, 4
A_burst:
  s_and_b32 s49, s38, 0xfffff
  s_or_b32 s49, s49, s70
  s_cmp_ge_u32 s38, s71
  s_cselect_b32 s49, 0x10000000, s49
  s_waitcnt vmcnt(8)
  s_add_u32 m0, s46, 0
  s_nop 0
  buffer_load_dwordx4 v4, s[16:19], s49 offen offset:0 nt lds
  s_add_u32 m0, s46, 960
  s_nop 0
  buffer_load_dwordx4 v4, s[16:19], s49 offen offset:64 nt lds
  s_add_u32 m0, s46, 1920
  s_nop 0
  buffer_load_dwordx4 v4, s[16:19], s49 offen offset:128 nt lds
  s_add_u32 m0, s46, 2880
  s_nop 0
  buffer_load_dwordx4 v4, s[16:19], s49 offen offset:192 nt lds
  s_add_u32 m0, s46, 3840
  s_nop 0
  buffer_load_dwordx4 v4, s[16:19], s49 offen offset:256 nt lds
  s_add_u32 m0, s46, 4800
  s_nop 0
  buffer_load_dwordx4 v4, s[16:19], s49 offen offset:320 nt lds
  s_add_u32 m0, s46, 5760
  s_nop 0
  buffer_load_dwordx4 v4, s[16:19], s49 offen offset:384 nt lds
  s_add_u32 m0, s46, 6720
  s_nop 0
  buffer_load_dwordx4 v4, s[16:19], s49 offen offset:448 nt lds
  s_waitcnt vmcnt(8)
  s_add_u32 m0, s46, 8192
  s_nop 0
  buffer_load_dwordx4 v5, s[20:23], s49 offen offset:0 nt lds
  s_add_u32 m0, s46, 8960
  s_nop 0
  buffer_load_dwordx4 v5, s[20:23], s49 offen offset:256 nt lds
  s_add_u32 m0, s46, 9728
  s_nop 0
  buffer_load_dwordx4 v5, s[20:23], s49 offen offset:512 nt lds
  s_add_u32 m0, s46, 10496
  s_nop 0
  buffer_load_dwordx4 v5, s[20:23], s49 offen offset:768 nt lds
  s_add_u32 m0, s46, 11264
  s_nop 0
  buffer_load_dwordx4 v5, s[20:23], s49 offen offset:1024 nt lds
  s_add_u32 m0, s46, 12032
  s_nop 0
  buffer_load_dwordx4 v5, s[20:23], s49 offen offset:1280 nt lds
  s_add_u32 m0, s46, 12800
  s_nop 0
  buffer_load_dwordx4 v5, s[20:23], s49 offen offset:1536 nt lds
  s_add_u32 m0, s46, 13568
  s_nop 0
  buffer_load_dwordx4 v5, s[20:23], s49 offen offset:1792 nt lds
  s_add_u32 s38, s38, 16384
  s_add_u32 s46, s46, 32768
  s_sub_u32 s47, s47, 1
  s_cmp_lg_u32 s47, 0
  s_cbranch_scc1 A_burst
  s_and_b32 s49, s38, 0xfffff
  s_or_b32 s49, s49, s70
  s_cmp_ge_u32 s38, s71
  s_cselect_b32 s49, 0x10000000, s49
  s_waitcnt vmcnt(8)
  buffer_load_dwordx4 a[64:67], v4, s[16:19], s49 offen offset:0 nt
  buffer_load_dwordx4 a[68:71], v4, s[16:19], s49 offen offset:64 nt
  buffer_load_dwordx4 a[72:75], v4, s[16:19], s49 offen offset:128 nt
  buffer_load_dwordx4 a[76:79], v4, s[16:19], s49 offen offset:192 nt
  buffer_load_dwordx4 a[80:83], v4, s[16:19], s49 offen offset:256 nt
  buffer_load_dwordx4 a[84:87], v4, s[16:19], s49 offen offset:320 nt
  buffer_load_dwordx4 a[88:91], v4, s[16:19], s49 offen offset:384 nt
  buffer_load_dwordx4 a[92:95], v4, s[16:19], s49 offen offset:448 nt
  s_waitcnt vmcnt(8)
  buffer_load_dwordx4 a[96:99], v5, s[20:23], s49 offen offset:0 nt
  buffer_load_dwordx4 a[100:103], v5, s[20:23], s49 offen offset:256 nt
  buffer_load_dwordx4 a[104:107], v5, s[20:23], s49 offen offset:512 nt
  buffer_load_dwordx4 a[108:111], v5, s[20:23], s49 offen offset:768 nt
  buffer_load_dwordx4 a[112:115], v5, s[20:23], s49 offen offset:1024 nt
  buffer_load_dwordx4 a[116:119], v5, s[20:23], s49 offen offset:1280 nt
  buffer_load_dwordx4 a[120:123], v5, s[20:23], s49 offen offset:1536 nt
  buffer_load_dwordx4 a[124:127], v5, s[20:23], s49 offen offset:1792 nt
  s_add_u32 s38, s38, 16384
  s_and_b32 s49, s38, 0xfffff
  s_or_b32 s49, s49, s70
  s_cmp_ge_u32 s38, s71
  s_cselect_b32 s49, 0x10000000, s49
  s_waitcnt vmcnt(8)
  buffer_load_dwordx4 a[128:131], v4, s[16:19], s49 offen offset:0 nt
  buffer_load_dwordx4 a[132:135], v4, s[16:19], s49 offen offset:64 nt
  buffer_load_dwordx4 a[136:139], v4, s[16:19], s49 offen offset:128 nt
  buffer_load_dwordx4 a[140:143], v4, s[16:19], s49 offen offset:192 nt
  buffer_load_dwordx4 a[144:147], v4, s[16:19], s49 offen offset:256 nt
  buffer_load_dwordx4 a[148:151], v4, s[16:19], s49 offen offset:320 nt
  buffer_load_dwordx4 a[152:155], v4, s[16:19], s49 offen offset:384 nt
  buffer_load_dwordx4 a[156:159], v4, s[16:19], s49 offen offset:448 nt
  s_waitcnt vmcnt(8)
  buffer_load_dwordx4 a[160:163], v5, s[20:23], s49 offen offset:0 nt
  buffer_load_dwordx4 a[164:167], v5, s[20:23], s49 offen offset:256 nt
  buffer_load_dwordx4 a[168:171], v5, s[20:23], s49 offen offset:512 nt
  buffer_load_dwordx4 a[172:175], v5, s[20:23], s49 offen offset:768 nt
  buffer_load_dwordx4 a[176:179], v5, s[20:23], s49 offen offset:1024 nt
  buffer_load_dwordx4 a[180:183], v5, s[20:23], s49 offen offset:1280 nt
  buffer_load_dwordx4 a[184:187], v5, s[20:23], s49 offen offset:1536 nt
  buffer_load_dwordx4 a[188:191], v5, s[20:23], s49 offen offset:1792 nt
  s_add_u32 s38, s38, 16384
  s_and_b32 s49, s38, 0xfffff
  s_or_b32 s49, s49, s70
  s_cmp_ge_u32 s38, s71
  s_cselect_b32 s49, 0x10000000, s49
  s_waitcnt vmcnt(8)
  buffer_load_dwordx4 a[192:195], v4, s[16:19], s49 offen offset:0 nt
  buffer_load_dwordx4 a[196:199], v4, s[16:19], s49 offen offset:64 nt
  buffer_load_dwordx4 a[200:203], v4, s[16:19], s49 offen offset:128 nt
  buffer_load_dwordx4 a[204:207], v4, s[16:19], s49 offen offset:192 nt
  buffer_load_dwordx4 a[208:211], v4, s[16:19], s49 offen offset:256 nt
  buffer_load_dwordx4 a[212:215], v4, s[16:19], s49 offen offset:320 nt
  buffer_load_dwordx4 a[216:219], v4, s[16:19], s49 offen offset:384 nt
  buffer_load_dwordx4 a[220:223], v4, s[16:19], s49 offen offset:448 nt
  s_waitcnt vmcnt(8)
  buffer_load_dwordx4 a[224:227], v5, s[20:23], s49 offen offset:0 nt
  buffer_load_dwordx4 a[228:231], v5, s[20:23], s49 offen offset:256 nt
  buffer_load_dwordx4 a[232:235], v5, s[20:23], s49 offen offset:512 nt
  buffer_load_dwordx4 a[236:239], v5, s[20:23], s49 offen offset:768 nt
  buffer_load_dwordx4 a[240:243], v5, s[20:23], s49 offen offset:1024 nt
  buffer_load_dwordx4 a[244:247], v5, s[20:23], s49 offen offset:1280 nt
  buffer_load_dwordx4 a[248:251], v5, s[20:23], s49 offen offset:1536 nt
  buffer_load_dwordx4 a[252:255], v5, s[20:23], s49 offen offset:1792 nt
  s_add_u32 s38, s38, 16384
  s_and_b32 s49, s38, 0xfffff
  s_or_b32 s49, s49, s70
  s_cmp_ge_u32 s38, s71
  s_cselect_b32 s49, 0x10000000, s49
  s_waitcnt vmcnt(8)
  buffer_load_dwordx4 v[80:83], v4, s[16:19], s49 offen offset:0 nt
  buffer_load_dwordx4 v[84:87], v4, s[16:19], s49 offen offset:64 nt
  buffer_load_dwordx4 v[88:91], v4, s[16:19], s49 offen offset:128 nt
  buffer_load_dwordx4 v[92:95], v4, s[16:19], s49 offen offset:192 nt
  buffer_load_dwordx4 v[96:99], v4, s[16:19], s49 offen offset:256 nt
  buffer_load_dwordx4 v[100:103], v4, s[16:19], s49 offen offset:320 nt
  buffer_load_dwordx4 v[104:107], v4, s[16:19], s49 offen offset:384 nt
  buffer_load_dwordx4 v[108:111], v4, s[16:19], s49 offen offset:448 nt
  s_waitcnt vmcnt(8)
  buffer_load_dwordx4 v[112:115], v5, s[20:23], s49 offen offset:0 nt
  buffer_load_dwordx4 v[116:119], v5, s[20:23], s49 offen offset:256 nt
  buffer_load_dwordx4 v[120:123], v5, s[20:23], s49 offen offset:512 nt
  buffer_load_dwordx4 v[124:127], v5, s[20:23], s49 offen offset:768 nt
  buffer_load_dwordx4 v[128:131], v5, s[20:23], s49 offen offset:1024 nt
  buffer_load_dwordx4 v[132:135], v5, s[20:23], s49 offen offset:1280 nt
  buffer_load_dwordx4 v[136:139], v5, s[20:23], s49 offen offset:1536 nt
  buffer_load_dwordx4 v[140:143], v5, s[20:23], s49 offen offset:1792 nt
  s_add_u32 s38, s38, 16384
  s_and_b32 s49, s38, 0xfffff
  s_or_b32 s49, s49, s70
  s_cmp_ge_u32 s38, s71
  s_cselect_b32 s49, 0x10000000, s49
  s_waitcnt vmcnt(8)
  buffer_load_dwordx4 v[144:147], v4, s[16:19], s49 offen offset:0 nt
  buffer_load_dwordx4 v[148:151], v4, s[16:19], s49 offen offset:64 nt
  buffer_load_dwordx4 v[152:155], v4, s[16:19], s49 offen offset:128 nt
  buffer_load_dwordx4 v[156:159], v4, s[16:19], s49 offen offset:192 nt
  buffer_load_dwordx4 v[160:163], v4, s[16:19], s49 offen offset:256 nt
  buffer_load_dwordx4 v[164:167], v4, s[16:19], s49 offen offset:320 nt
  buffer_load_dwordx4 v[168:171], v4, s[16:19], s49 offen offset:384 nt
  buffer_load_dwordx4 v[172:175], v4, s[16:19], s49 offen offset:448 nt
  s_waitcnt vmcnt(8)
  buffer_load_dwordx4 v[176:179], v5, s[20:23], s49 offen offset:0 nt
  buffer_load_dwordx4 v[180:183], v5, s[20:23], s49 offen offset:256 nt
  buffer_load_dwordx4 v[184:187], v5, s[20:23], s49 offen offset:512 nt
  buffer_load_dwordx4 v[188:191], v5, s[20:23], s49 offen offset:768 nt
  buffer_load_dwordx4 v[192:195], v5, s[20:23], s49 offen offset:1024 nt
  buffer_load_dwordx4 v[196:199], v5, s[20:23], s49 offen offset:1280 nt
  buffer_load_dwordx4 v[200:203], v5, s[20:23], s49 offen offset:1536 nt
  buffer_load_dwordx4 v[204:207], v5, s[20:23], s49 offen offset:1792 nt
  s_add_u32 s38, s38, 16384
  s_and_b32 s49, s38, 0xfffff
  s_or_b32 s49, s49, s70
  s_cmp_ge_u32 s38, s71
  s_cselect_b32 s49, 0x10000000, s49
  s_waitcnt vmcnt(8)
  buffer_load_dwordx4 a[0:3], v4, s[16:19], s49 offen offset:0 nt
  buffer_load_dwordx4 a[4:7], v4, s[16:19], s49 offen offset:64 nt
  buffer_load_dwordx4 a[8:11], v4, s[16:19], s49 offen offset:128 nt
  buffer_load_dwordx4 a[12:15], v4, s[16:19], s49 offen offset:192 nt
  buffer_load_dwordx4 a[16:19], v4, s[16:19], s49 offen offset:256 nt
  buffer_load_dwordx4 a[20:23], v4, s[16:19], s49 offen offset:320 nt
  buffer_load_dwordx4 a[24:27], v4, s[16:19], s49 offen offset:384 nt
  buffer_load_dwordx4 a[28:31], v4, s[16:19], s49 offen offset:448 nt
  s_waitcnt vmcnt(8)
  buffer_load_dwordx4 a[32:35], v5, s[20:23], s49 offen offset:0 nt
  buffer_load_dwordx4 a[36:39], v5, s[20:23], s49 offen offset:256 nt
  buffer_load_dwordx4 a[40:43], v5, s[20:23], s49 offen offset:512 nt
  buffer_load_dwordx4 a[44:47], v5, s[20:23], s49 offen offset:768 nt
  buffer_load_dwordx4 a[48:51], v5, s[20:23], s49 offen offset:1024 nt
  buffer_load_dwordx4 a[52:55], v5, s[20:23], s49 offen offset:1280 nt
  buffer_load_dwordx4 a[56:59], v5, s[20:23], s49 offen offset:1536 nt
  buffer_load_dwordx4 a[60:63], v5, s[20:23], s49 offen offset:1792 nt
  s_add_u32 s38, s38, 16384
  s_waitcnt vmcnt(48)
  s_branch A_join
A_helper:
  s_load_dwordx2 s[54:55], s[0:1], 72
  s_mov_b32 s28, s32
  s_mov_b32 s29, s33
  s_mov_b32 s30, 0x400000
  s_mov_b32 s31, 0x00020000
  s_cmp_eq_u32 s3, 3
  s_cbranch_scc1 A_fetch
  s_lshl_b32 s57, s36, 2
  s_add_u32 s57, s57, s35
  s_and_b32 s56, s57, 1
  s_lshr_b32 s57, s57, 1
  s_lshl_b32 s58, s34, 3
  s_add_u32 s58, s58, s57
  s_mov_b32 s12, s4
  s_mov_b32 s13, s5
  s_mov_b32 s14, 3584
  s_mov_b32 s15, 0x00020000
  s_mov_b32 s24, s10
  s_mov_b32 s25, s11
  s_mov_b32 s26, 3670016
  s_mov_b32 s27, 0x00020000
  v_mul_u32_u24 v7, 896, v3
  v_mul_u32_u24 v6, 56, v2
  v_add_u32 v7, v7, v6
  buffer_load_dwordx4 v[48:51], v7, s[12:15], 0 offen
  buffer_load_dwordx4 v[52:55], v7, s[12:15], 0 offen offset:16
  buffer_load_dwordx4 v[56:59], v7, s[12:15], 0 offen offset:32
  buffer_load_dwordx2 v[60:61], v7, s[12:15], 0 offen offset:48
  v_lshrrev_b32 v6, 2, v2
  v_lshl_add_u32 v6, v6, 2, v3
  v_lshlrev_b32 v6, 16, v6
  v_and_b32 v44, 3, v2
  v_lshl_add_u32 v6, v44, 4, v6
  s_lshl_b32 s43, s58, 6
  s_lshl_b32 s57, s56, 21
  s_add_u32 s43, s43, s57
  buffer_load_dwordx4 v[80:83], v6, s[24:27], s43 offen
  s_add_u32 s43, s43, 8192
  buffer_load_dwordx4 v[84:87], v6, s[24:27], s43 offen
  s_add_u32 s43, s43, 8192
  buffer_load_dwordx4 v[88:91], v6, s[24:27], s43 offen
  s_add_u32 s43, s43, 8192
  buffer_load_dwordx4 v[92:95], v6, s[24:27], s43 offen
  s_add_u32 s43, s43, 8192
  buffer_load_dwordx4 v[96:99], v6, s[24:27], s43 offen
  s_add_u32 s43, s43, 8192
  buffer_load_dwordx4 v[100:103], v6, s[24:27], s43 offen
  s_add_u32 s43, s43, 8192
  buffer_load_dwordx4 v[104:107], v6, s[24:27], s43 offen
  s_add_u32 s43, s43, 8192
  buffer_load_dwordx4 v[108:111], v6, s[24:27], s43 offen
  s_add_u32 s43, s43, 991232
  buffer_load_dwordx4 v[112:115], v6, s[24:27], s43 offen
  s_add_u32 s43, s43, 8192
  buffer_load_dwordx4 v[116:119], v6, s[24:27], s43 offen
  s_add_u32 s43, s43, 8192
  buffer_load_dwordx4 v[120:123], v6, s[24:27], s43 offen
  s_add_u32 s43, s43, 8192
  buffer_load_dwordx4 v[124:127], v6, s[24:27], s43 offen
  s_add_u32 s43, s43, 8192
  buffer_load_dwordx4 v[128:131], v6, s[24:27], s43 offen
  s_add_u32 s43, s43, 8192
  buffer_load_dwordx4 v[132:135], v6, s[24:27], s43 offen
  s_add_u32 s43, s43, 8192
  buffer_load_dwordx4 v[136:139], v6, s[24:27], s43 offen
  s_add_u32 s43, s43, 8192
  buffer_load_dwordx4 v[140:143], v6, s[24:27], s43 offen
  s_add_u32 s43, s43, 991232
  s_waitcnt vmcnt(16)
  v_lshlrev_b32 v208, 16, v48
  v_and_b32 v209, 0xffff0000, v48
  v_lshlrev_b32 v210, 16, v49
  v_and_b32 v211, 0xffff0000, v49
  v_lshlrev_b32 v212, 16, v50
  v_and_b32 v213, 0xffff0000, v50
  v_lshlrev_b32 v214, 16, v51
  v_and_b32 v215, 0xffff0000, v51
  v_lshlrev_b32 v216, 16, v52
  v_and_b32 v217, 0xffff0000, v52
  v_lshlrev_b32 v218, 16, v53
  v_and_b32 v219, 0xffff0000, v53
  v_lshlrev_b32 v220, 16, v54
  v_and_b32 v221, 0xffff0000, v54
  v_lshlrev_b32 v222, 16, v55
  v_and_b32 v223, 0xffff0000, v55
  v_lshlrev_b32 v224, 16, v56
  v_and_b32 v225, 0xffff0000, v56
  v_lshlrev_b32 v226, 16, v57
  v_and_b32 v227, 0xffff0000, v57
  v_lshlrev_b32 v228, 16, v58
  v_and_b32 v229, 0xffff0000, v58
  v_lshlrev_b32 v230, 16, v59
  v_and_b32 v231, 0xffff0000, v59
  v_lshlrev_b32 v232, 16, v60
  v_and_b32 v233, 0xffff0000, v60
  v_lshlrev_b32 v234, 16, v61
  v_and_b32 v235, 0xffff0000, v61
  v_add_f32 v28, v208, v209
  v_add_f32 v29, v210, v211
  v_add_f32 v28, v28, v212
  v_add_f32 v29, v29, v213
  v_add_f32 v28, v28, v214
  v_add_f32 v29, v29, v215
  v_add_f32 v28, v28, v216
  v_add_f32 v29, v29, v217
  v_add_f32 v28, v28, v218
  v_add_f32 v29, v29, v219
  v_add_f32 v28, v28, v220
  v_add_f32 v29, v29, v221
  v_add_f32 v28, v28, v222
  v_add_f32 v29, v29, v223
  v_add_f32 v28, v28, v224
  v_add_f32 v29, v29, v225
  v_add_f32 v28, v28, v226
  v_add_f32 v29, v29, v227
  v_add_f32 v28, v28, v228
  v_add_f32 v29, v29, v229
  v_add_f32 v28, v28, v230
  v_add_f32 v29, v29, v231
  v_add_f32 v28, v28, v232
  v_add_f32 v29, v29, v233
  v_add_f32 v28, v28, v234
  v_add_f32 v29, v29, v235
  v_add_f32 v28, v28, v29
  s_nop 1
  v_add_f32_dpp v28, v28, v28 quad_perm:[1,0,3,2] row_mask:0xf bank_mask:0xf
  s_nop 1
  v_add_f32_dpp v28, v28, v28 quad_perm:[2,3,0,1] row_mask:0xf bank_mask:0xf
  s_nop 1
  v_add_f32_dpp v28, v28, v28 row_half_mirror row_mask:0xf bank_mask:0xf
  s_nop 1
  v_add_f32_dpp v28, v28, v28 row_mirror row_mask:0xf bank_mask:0xf
  v_mul_f32 v28, 0x3b124925, v28
  v_sub_f32 v30, v208, v28
  v_sub_f32 v31, v209, v28
  v_mul_f32 v29, v30, v30
  v_mul_f32 v32, v31, v31
  v_sub_f32 v30, v210, v28
  v_sub_f32 v31, v211, v28
  v_fma_f32 v29, v30, v30, v29
  v_fma_f32 v32, v31, v31, v32
  v_sub_f32 v30, v212, v28
  v_sub_f32 v31, v213, v28
  v_fma_f32 v29, v30, v30, v29
  v_fma_f32 v32, v31, v31, v32
  v_sub_f32 v30, v214, v28
  v_sub_f32 v31, v215, v28
  v_fma_f32 v29, v30, v30, v29
  v_fma_f32 v32, v31, v31, v32
  v_sub_f32 v30, v216, v28
  v_sub_f32 v31, v217, v28
  v_fma_f32 v29, v30, v30, v29
  v_fma_f32 v32, v31, v31, v32
  v_sub_f32 v30, v218, v28
  v_sub_f32 v31, v219, v28
  v_fma_f32 v29, v30, v30, v29
  v_fma_f32 v32, v31, v31, v32
  v_sub_f32 v30, v220, v28
  v_sub_f32 v31, v221, v28
  v_fma_f32 v29, v30, v30, v29
  v_fma_f32 v32, v31, v31, v32
  v_sub_f32 v30, v222, v28
  v_sub_f32 v31, v223, v28
  v_fma_f32 v29, v30, v30, v29
  v_fma_f32 v32, v31, v31, v32
  v_sub_f32 v30, v224, v28
  v_sub_f32 v31, v225, v28
  v_fma_f32 v29, v30, v30, v29
  v_fma_f32 v32, v31, v31, v32
  v_sub_f32 v30, v226, v28
  v_sub_f32 v31, v227, v28
  v_fma_f32 v29, v30, v30, v29
  v_fma_f32 v32, v31, v31, v32
  v_sub_f32 v30, v228, v28
  v_sub_f32 v31, v229, v28
  v_fma_f32 v29, v30, v30, v29
  v_fma_f32 v32, v31, v31, v32
  v_sub_f32 v30, v230, v28
  v_sub_f32 v31, v231, v28
  v_fma_f32 v29, v30, v30, v29
  v_fma_f32 v32, v31, v31, v32
  v_sub_f32 v30, v232, v28
  v_sub_f32 v31, v233, v28
  v_fma_f32 v29, v30, v30, v29
  v_fma_f32 v32, v31, v31, v32
  v_sub_f32 v30, v234, v28
  v_sub_f32 v31, v235, v28
  v_fma_f32 v29, v30, v30, v29
  v_fma_f32 v32, v31, v31, v32
  v_add_f32 v29, v29, v32
  s_nop 1
  v_add_f32_dpp v29, v29, v29 quad_perm:[1,0,3,2] row_mask:0xf bank_mask:0xf
  s_nop 1
  v_add_f32_dpp v29, v29, v29 quad_perm:[2,3,0,1] row_mask:0xf bank_mask:0xf
  s_nop 1
  v_add_f32_dpp v29, v29, v29 row_half_mirror row_mask:0xf bank_mask:0xf
  s_nop 1
  v_add_f32_dpp v29, v29, v29 row_mirror row_mask:0xf bank_mask:0xf
  v_mul_f32 v29, 0x3b124925, v29
  v_cvt_pk_bf16_f32 v28, v28, v28
  v_lshlrev_b32 v28, 16, v28
  v_cvt_pk_bf16_f32 v29, v29, v29
  v_lshlrev_b32 v29, 16, v29
  v_add_f32 v29, 0x3727c5ac, v29
  v_cvt_pk_bf16_f32 v29, v29, v29
  v_lshlrev_b32 v29, 16, v29
  v_sqrt_f32 v29, v29
  s_nop 0
  v_cvt_pk_bf16_f32 v29, v29, v29
  v_lshlrev_b32 v29, 16, v29
  v_rcp_f32 v30, v29
  v_sub_f32 v31, v208, v28
  v_sub_f32 v32, v209, v28
  v_cvt_pk_bf16_f32 v33, v31, v32
  v_lshlrev_b32 v31, 16, v33
  v_and_b32 v32, 0xffff0000, v33
  v_mul_f32 v34, v31, v30
  v_mul_f32 v35, v32, v30
  v_fma_f32 v36, -v34, v29, v31
  v_fma_f32 v37, -v35, v29, v32
  v_fma_f32 v34, v36, v30, v34
  v_fma_f32 v35, v37, v30, v35
  v_cvt_pk_bf16_f32 v48, v34, v35
  v_sub_f32 v31, v210, v28
  v_sub_f32 v32, v211, v28
  v_cvt_pk_bf16_f32 v33, v31, v32
  v_lshlrev_b32 v31, 16, v33
  v_and_b32 v32, 0xffff0000, v33
  v_mul_f32 v34, v31, v30
  v_mul_f32 v35, v32, v30
  v_fma_f32 v36, -v34, v29, v31
  v_fma_f32 v37, -v35, v29, v32
  v_fma_f32 v34, v36, v30, v34
  v_fma_f32 v35, v37, v30, v35
  v_cvt_pk_bf16_f32 v49, v34, v35
  v_sub_f32 v31, v212, v28
  v_sub_f32 v32, v213, v28
  v_cvt_pk_bf16_f32 v33, v31, v32
  v_lshlrev_b32 v31, 16, v33
  v_and_b32 v32, 0xffff0000, v33
  v_mul_f32 v34, v31, v30
  v_mul_f32 v35, v32, v30
  v_fma_f32 v36, -v34, v29, v31
  v_fma_f32 v37, -v35, v29, v32
  v_fma_f32 v34, v36, v30, v34
  v_fma_f32 v35, v37, v30, v35
  v_cvt_pk_bf16_f32 v50, v34, v35
  v_sub_f32 v31, v214, v28
  v_sub_f32 v32, v215, v28
  v_cvt_pk_bf16_f32 v33, v31, v32
  v_lshlrev_b32 v31, 16, v33
  v_and_b32 v32, 0xffff0000, v33
  v_mul_f32 v34, v31, v30
  v_mul_f32 v35, v32, v30
  v_fma_f32 v36, -v34, v29, v31
  v_fma_f32 v37, -v35, v29, v32
  v_fma_f32 v34, v36, v30, v34
  v_fma_f32 v35, v37, v30, v35
  v_cvt_pk_bf16_f32 v51, v34, v35
  v_sub_f32 v31, v216, v28
  v_sub_f32 v32, v217, v28
  v_cvt_pk_bf16_f32 v33, v31, v32
  v_lshlrev_b32 v31, 16, v33
  v_and_b32 v32, 0xffff0000, v33
  v_mul_f32 v34, v31, v30
  v_mul_f32 v35, v32, v30
  v_fma_f32 v36, -v34, v29, v31
  v_fma_f32 v37, -v35, v29, v32
  v_fma_f32 v34, v36, v30, v34
  v_fma_f32 v35, v37, v30, v35
  v_cvt_pk_bf16_f32 v52, v34, v35
  v_sub_f32 v31, v218, v28
  v_sub_f32 v32, v219, v28
  v_cvt_pk_bf16_f32 v33, v31, v32
  v_lshlrev_b32 v31, 16, v33
  v_and_b32 v32, 0xffff0000, v33
  v_mul_f32 v34, v31, v30
  v_mul_f32 v35, v32, v30
  v_fma_f32 v36, -v34, v29, v31
  v_fma_f32 v37, -v35, v29, v32
  v_fma_f32 v34, v36, v30, v34
  v_fma_f32 v35, v37, v30, v35
  v_cvt_pk_bf16_f32 v53, v34, v35
  v_sub_f32 v31, v220, v28
  v_sub_f32 v32, v221, v28
  v_cvt_pk_bf16_f32 v33, v31, v32
  v_lshlrev_b32 v31, 16, v33
  v_and_b32 v32, 0xffff0000, v33
  v_mul_f32 v34, v31, v30
  v_mul_f32 v35, v32, v30
  v_fma_f32 v36, -v34, v29, v31
  v_fma_f32 v37, -v35, v29, v32
  v_fma_f32 v34, v36, v30, v34
  v_fma_f32 v35, v37, v30, v35
  v_cvt_pk_bf16_f32 v54, v34, v35
  v_sub_f32 v31, v222, v28
  v_sub_f32 v32, v223, v28
  v_cvt_pk_bf16_f32 v33, v31, v32
  v_lshlrev_b32 v31, 16, v33
  v_and_b32 v32, 0xffff0000, v33
  v_mul_f32 v34, v31, v30
  v_mul_f32 v35, v32, v30
  v_fma_f32 v36, -v34, v29, v31
  v_fma_f32 v37, -v35, v29, v32
  v_fma_f32 v34, v36, v30, v34
  v_fma_f32 v35, v37, v30, v35
  v_cvt_pk_bf16_f32 v55, v34, v35
  v_sub_f32 v31, v224, v28
  v_sub_f32 v32, v225, v28
  v_cvt_pk_bf16_f32 v33, v31, v32
  v_lshlrev_b32 v31, 16, v33
  v_and_b32 v32, 0xffff0000, v33
  v_mul_f32 v34, v31, v30
  v_mul_f32 v35, v32, v30
  v_fma_f32 v36, -v34, v29, v31
  v_fma_f32 v37, -v35, v29, v32
  v_fma_f32 v34, v36, v30, v34
  v_fma_f32 v35, v37, v30, v35
  v_cvt_pk_bf16_f32 v56, v34, v35
  v_sub_f32 v31, v226, v28
  v_sub_f32 v32, v227, v28
  v_cvt_pk_bf16_f32 v33, v31, v32
  v_lshlrev_b32 v31, 16, v33
  v_and_b32 v32, 0xffff0000, v33
  v_mul_f32 v34, v31, v30
  v_mul_f32 v35, v32, v30
  v_fma_f32 v36, -v34, v29, v31
  v_fma_f32 v37, -v35, v29, v32
  v_fma_f32 v34, v36, v30, v34
  v_fma_f32 v35, v37, v30, v35
  v_cvt_pk_bf16_f32 v57, v34, v35
  v_sub_f32 v31, v228, v28
  v_sub_f32 v32, v229, v28
  v_cvt_pk_bf16_f32 v33, v31, v32
  v_lshlrev_b32 v31, 16, v33
  v_and_b32 v32, 0xffff0000, v33
  v_mul_f32 v34, v31, v30
  v_mul_f32 v35, v32, v30
  v_fma_f32 v36, -v34, v29, v31
  v_fma_f32 v37, -v35, v29, v32
  v_fma_f32 v34, v36, v30, v34
  v_fma_f32 v35, v37, v30, v35
  v_cvt_pk_bf16_f32 v58, v34, v35
  v_sub_f32 v31, v230, v28
  v_sub_f32 v32, v231, v28
  v_cvt_pk_bf16_f32 v33, v31, v32
  v_lshlrev_b32 v31, 16, v33
  v_and_b32 v32, 0xffff0000, v33
  v_mul_f32 v34, v31, v30
  v_mul_f32 v35, v32, v30
  v_fma_f32 v36, -v34, v29, v31
  v_fma_f32 v37, -v35, v29, v32
  v_fma_f32 v34, v36, v30, v34
  v_fma_f32 v35, v37, v30, v35
  v_cvt_pk_bf16_f32 v59, v34, v35
  v_sub_f32 v31, v232, v28
  v_sub_f32 v32, v233, v28
  v_cvt_pk_bf16_f32 v33, v31, v32
  v_lshlrev_b32 v31, 16, v33
  v_and_b32 v32, 0xffff0000, v33
  v_mul_f32 v34, v31, v30
  v_mul_f32 v35, v32, v30
  v_fma_f32 v36, -v34, v29, v31
  v_fma_f32 v37, -v35, v29, v32
  v_fma_f32 v34, v36, v30, v34
  v_fma_f32 v35, v37, v30, v35
  v_cvt_pk_bf16_f32 v60, v34, v35
  v_sub_f32 v31, v234, v28
  v_sub_f32 v32, v235, v28
  v_cvt_pk_bf16_f32 v33, v31, v32
  v_lshlrev_b32 v31, 16, v33
  v_and_b32 v32, 0xffff0000, v33
  v_mul_f32 v34, v31, v30
  v_mul_f32 v35, v32, v30
  v_fma_f32 v36, -v34, v29, v31
  v_fma_f32 v37, -v35, v29, v32
  v_fma_f32 v34, v36, v30, v34
  v_fma_f32 v35, v37, v30, v35
  v_cvt_pk_bf16_f32 v61, v34, v35
  v_mul_u32_u24 v44, 56, v2
  v_lshl_add_u32 v44, v3, 10, v44
  v_add_u32 v44, 131072, v44
  ds_write_b64 v44, v[48:49] offset:0
  ds_write_b64 v44, v[50:51] offset:8
  ds_write_b64 v44, v[52:53] offset:16
  ds_write_b64 v44, v[54:55] offset:24
  ds_write_b64 v44, v[56:57] offset:32
  ds_write_b64 v44, v[58:59] offset:40
  ds_write_b64 v44, v[60:61] offset:48
  v_lshlrev_b32 v45, 3, v2
  v_lshl_add_u32 v45, v3, 10, v45
  v_add_u32 v45, 131968, v45
  v_mov_b32 v46, 0
  v_mov_b32 v47, 0
  ds_write_b64 v45, v[46:47]
  v_and_b32 v44, 3, v2
  v_lshlrev_b32 v44, 10, v44
  v_lshrrev_b32 v45, 2, v2
  v_lshl_add_u32 v45, v45, 2, v3
  v_lshl_add_u32 v44, v45, 4, v44
  s_lshl_b32 s57, s56, 9
  s_add_u32 s57, s57, 131072
  v_add_u32 v44, s57, v44
  s_mov_b32 s46, 0x05040100
  s_mov_b32 s47, 0x07060302
  s_waitcnt lgkmcnt(0)
  s_mov_b32 s60, s54
  s_mov_b32 s61, s55
  s_mov_b32 s62, 256
  s_mov_b32 s63, 0x00020000
  buffer_load_dword v47, v46, s[60:63], 0 offen sc1
  ds_read_b128 v[28:31], v44 offset:0
  ds_read_b128 v[32:35], v44 offset:256
  s_waitcnt vmcnt(9)
  v_perm_b32 v208, v84, v80, s46
  v_perm_b32 v212, v84, v80, s47
  v_perm_b32 v209, v92, v88, s46
  v_perm_b32 v213, v92, v88, s47
  v_perm_b32 v210, v100, v96, s46
  v_perm_b32 v214, v100, v96, s47
  v_perm_b32 v211, v108, v104, s46
  v_perm_b32 v215, v108, v104, s47
  v_perm_b32 v216, v85, v81, s46
  v_perm_b32 v220, v85, v81, s47
  v_perm_b32 v217, v93, v89, s46
  v_perm_b32 v221, v93, v89, s47
  v_perm_b32 v218, v101, v97, s46
  v_perm_b32 v222, v101, v97, s47
  v_perm_b32 v219, v109, v105, s46
  v_perm_b32 v223, v109, v105, s47
  v_perm_b32 v224, v86, v82, s46
  v_perm_b32 v228, v86, v82, s47
  v_perm_b32 v225, v94, v90, s46
  v_perm_b32 v229, v94, v90, s47
  v_perm_b32 v226, v102, v98, s46
  v_perm_b32 v230, v102, v98, s47
  v_perm_b32 v227, v110, v106, s46
  v_perm_b32 v231, v110, v106, s47
  v_perm_b32 v232, v87, v83, s46
  v_perm_b32 v236, v87, v83, s47
  v_perm_b32 v233, v95, v91, s46
  v_perm_b32 v237, v95, v91, s47
  v_perm_b32 v234, v103, v99, s46
  v_perm_b32 v238, v103, v99, s47
  v_perm_b32 v235, v111, v107, s46
  v_perm_b32 v239, v111, v107, s47
  s_waitcnt lgkmcnt(0)
  s_nop 0
  v_mfma_f32_16x16x32_bf16 v[48:51], v[28:31], v[208:211], 0
  v_mfma_f32_16x16x32_bf16 v[52:55], v[28:31], v[212:215], 0
  v_mfma_f32_16x16x32_bf16 v[56:59], v[28:31], v[216:219], 0
  v_mfma_f32_16x16x32_bf16 v[60:63], v[28:31], v[220:223], 0
  v_mfma_f32_16x16x32_bf16 v[64:67], v[28:31], v[224:227], 0
  v_mfma_f32_16x16x32_bf16 v[68:71], v[28:31], v[228:231], 0
  v_mfma_f32_16x16x32_bf16 v[72:75], v[28:31], v[232:235], 0
  v_mfma_f32_16x16x32_bf16 v[76:79], v[28:31], v[236:239], 0
  s_waitcnt vmcnt(1)
  v_perm_b32 v208, v116, v112, s46
  v_perm_b32 v212, v116, v112, s47
  v_perm_b32 v209, v124, v120, s46
  v_perm_b32 v213, v124, v120, s47
  v_perm_b32 v210, v132, v128, s46
  v_perm_b32 v214, v132, v128, s47
  v_perm_b32 v211, v140, v136, s46
  v_perm_b32 v215, v140, v136, s47
  v_perm_b32 v216, v117, v113, s46
  v_perm_b32 v220, v117, v113, s47
  v_perm_b32 v217, v125, v121, s46
  v_perm_b32 v221, v125, v121, s47
  v_perm_b32 v218, v133, v129, s46
  v_perm_b32 v222, v133, v129, s47
  v_perm_b32 v219, v141, v137, s46
  v_perm_b32 v223, v141, v137, s47
  v_perm_b32 v224, v118, v114, s46
  v_perm_b32 v228, v118, v114, s47
  v_perm_b32 v225, v126, v122, s46
  v_perm_b32 v229, v126, v122, s47
  v_perm_b32 v226, v134, v130, s46
  v_perm_b32 v230, v134, v130, s47
  v_perm_b32 v227, v142, v138, s46
  v_perm_b32 v231, v142, v138, s47
  v_perm_b32 v232, v119, v115, s46
  v_perm_b32 v236, v119, v115, s47
  v_perm_b32 v233, v127, v123, s46
  v_perm_b32 v237, v127, v123, s47
  v_perm_b32 v234, v135, v131, s46
  v_perm_b32 v238, v135, v131, s47
  v_perm_b32 v235, v143, v139, s46
  v_perm_b32 v239, v143, v139, s47
  s_waitcnt lgkmcnt(0)
  s_nop 0
  v_mfma_f32_16x16x32_bf16 v[48:51], v[32:35], v[208:211], v[48:51]
  v_mfma_f32_16x16x32_bf16 v[52:55], v[32:35], v[212:215], v[52:55]
  v_mfma_f32_16x16x32_bf16 v[56:59], v[32:35], v[216:219], v[56:59]
  v_mfma_f32_16x16x32_bf16 v[60:63], v[32:35], v[220:223], v[60:63]
  v_mfma_f32_16x16x32_bf16 v[64:67], v[32:35], v[224:227], v[64:67]
  v_mfma_f32_16x16x32_bf16 v[68:71], v[32:35], v[228:231], v[68:71]
  v_mfma_f32_16x16x32_bf16 v[72:75], v[32:35], v[232:235], v[72:75]
  v_mfma_f32_16x16x32_bf16 v[76:79], v[32:35], v[236:239], v[76:79]
  v_lshrrev_b32 v16, 2, v2
  v_cmp_eq_u32 vcc, v16, v3
  v_and_b32 v17, 3, v2
  v_lshlrev_b32 v17, 7, v17
  v_lshl_add_u32 v17, v16, 9, v17
  v_add_u32 v17, 135680, v17
  s_nop 4
  s_mov_b64 exec, vcc
  ds_write_b128 v17, v[48:51] offset:0
  ds_write_b128 v17, v[52:55] offset:16
  ds_write_b128 v17, v[56:59] offset:32
  ds_write_b128 v17, v[60:63] offset:48
  ds_write_b128 v17, v[64:67] offset:64
  ds_write_b128 v17, v[68:71] offset:80
  ds_write_b128 v17, v[72:75] offset:96
  ds_write_b128 v17, v[76:79] offset:112
  s_mov_b64 exec, -1
  v_lshlrev_b32 v17, 5, v2
  v_lshl_add_u32 v17, v3, 2, v17
  v_add_u32 v17, 135680, v17
  s_waitcnt lgkmcnt(0)
  ds_read_b32 v18, v17 offset:0
  ds_read_b32 v19, v17 offset:16
  ds_read_b32 v20, v17 offset:512
  ds_read_b32 v21, v17 offset:528
  ds_read_b32 v22, v17 offset:1024
  ds_read_b32 v23, v17 offset:1040
  ds_read_b32 v24, v17 offset:1536
  ds_read_b32 v25, v17 offset:1552
  v_lshlrev_b32 v28, 15, v3
  v_lshl_add_u32 v28, v2, 4, v28
  s_lshl_b32 s43, s58, 8
  s_lshl_b32 s57, s56, 17
  s_add_u32 s43, s43, s57
  s_add_u32 s43, s43, 1048576
  s_waitcnt lgkmcnt(0)
  v_add_f32 v18, v18, v20
  v_add_f32 v19, v19, v21
  v_add_f32 v22, v22, v24
  v_add_f32 v23, v23, v25
  v_add_f32 v32, v18, v22
  v_add_f32 v34, v19, v23
  s_mov_b32 s59, 200000
A_npoll:
  s_waitcnt vmcnt(0)
  v_readfirstlane_b32 s57, v47
  s_cmp_lg_u32 s57, 0
  s_cbranch_scc1 A_ngot
  s_sub_u32 s59, s59, 1
  s_cmp_eq_u32 s59, 0
  s_cbranch_scc1 A_ngot
  s_sleep 10
  buffer_load_dword v47, v46, s[60:63], 0 offen sc1
  s_branch A_npoll
A_ngot:
  v_mov_b32 v33, v47
  v_mov_b32 v35, v47
  buffer_store_dwordx4 v[32:35], v28, s[28:31], s43 offen sc1
  s_branch A_join
A_fetch:
  s_memrealtime s[66:67]
  s_waitcnt lgkmcnt(0)
  s_mov_b32 s60, s54
  s_mov_b32 s61, s55
  s_mov_b32 s62, 256
  s_mov_b32 s63, 0x00020000
  v_mov_b32 v6, 0
  s_cmp_lg_u32 s2, 0
  s_cbranch_scc1 A_nonw
  s_or_b32 s57, s66, 1
  v_mov_b32 v28, s57
  s_mov_b64 exec, 1
  buffer_store_dword v28, v6, s[60:63], 0 offen sc1
  s_mov_b64 exec, -1
  s_branch A_nonw2
A_nonw:
A_nonw2:
  s_sleep 127
  s_sleep 40
  s_mov_b32 s59, 200000
  s_lshl_b32 s43, s36, 15
  s_lshl_b32 s44, s34, 11
  s_add_u32 s43, s43, s44
  s_add_u32 s43, s43, 1048576
  s_add_u32 s44, s43, 131072
  v_lshlrev_b32 v7, 5, v1
A_poll:
  buffer_load_dword v44, v6, s[60:63], 0 offen sc1
  buffer_load_dwordx4 v[28:31], v7, s[28:31], s43 offen sc1
  buffer_load_dwordx4 v[32:35], v7, s[28:31], s43 offen offset:16 sc1
  buffer_load_dwordx4 v[36:39], v7, s[28:31], s44 offen sc1
  buffer_load_dwordx4 v[40:43], v7, s[28:31], s44 offen offset:16 sc1
  s_waitcnt vmcnt(0)
  v_xor_b32 v29, v29, v44
  v_xor_b32 v31, v31, v44
  v_xor_b32 v33, v33, v44
  v_xor_b32 v35, v35, v44
  v_xor_b32 v37, v37, v44
  v_xor_b32 v39, v39, v44
  v_xor_b32 v41, v41, v44
  v_xor_b32 v43, v43, v44
  v_or3_b32 v29, v29, v31, v33
  v_or3_b32 v35, v35, v37, v39
  v_or3_b32 v41, v41, v43, v29
  v_or_b32 v41, v41, v35
  v_cmp_eq_u32 vcc, 0, v41
  v_cmp_ne_u32 s[50:51], 0, v44
  s_and_b64 vcc, vcc, s[50:51]
  s_cmp_eq_u64 vcc, -1
  s_cbranch_scc1 A_ready
  s_sub_u32 s59, s59, 1
  s_cmp_eq_u32 s59, 0
  s_cbranch_scc1 A_ready
  s_sleep 40
  s_branch A_poll
A_ready:
  v_add_f32 v28, v28, v36
  v_add_f32 v30, v30, v38
  v_add_f32 v32, v32, v40
  v_add_f32 v34, v34, v42
  v_cvt_pk_bf16_f32 v28, v28, v30
  v_cvt_pk_bf16_f32 v29, v32, v34
  v_lshlrev_b32 v6, 3, v1
  v_add_u32 v6, 135168, v6
  ds_write_b64 v6, v[28:29]
  v_mov_b32 v6, 139840
  v_mov_b32 v45, 0
  ds_write_b64 v6, v[44:45]
  s_waitcnt lgkmcnt(0)
A_join:
  v_lshrrev_b32 v44, 1, v2
  v_and_b32 v45, 1, v2
  v_cmp_eq_u32 vcc, 1, v45
  v_mov_b32 v46, 0xffff
  v_mov_b32 v47, 0xffff0000
  v_cndmask_b32 v45, v46, v47, vcc
  v_cmp_eq_u32 vcc, 0, v44
  s_nop 1
  v_cndmask_b32 v8, 0, v45, vcc
  v_cmp_eq_u32 vcc, 1, v44
  s_nop 1
  v_cndmask_b32 v9, 0, v45, vcc
  v_cmp_eq_u32 vcc, 2, v44
  s_nop 1
  v_cndmask_b32 v10, 0, v45, vcc
  v_cmp_eq_u32 vcc, 3, v44
  s_nop 1
  v_cndmask_b32 v11, 0, v45, vcc
  v_mov_b32 v16, 0
  v_mov_b32 v17, 0
  v_mov_b32 v18, 0
  v_mov_b32 v19, 0
  v_mov_b32 v20, 0
  v_mov_b32 v21, 0
  v_mov_b32 v22, 0
  v_mov_b32 v23, 0
  v_mov_b32 v24, 0xff7fffff
  v_mov_b32 v25, 0xff7fffff
  v_mov_b32 v26, 0
  v_lshlrev_b32 v45, 4, v3
  v_add_u32 v45, 135168, v45
  s_waitcnt lgkmcnt(0)
  s_barrier
  ds_read_b128 v[48:51], v45 offset:0
  ds_read_b128 v[52:55], v45 offset:64
  ds_read_b128 v[56:59], v45 offset:128
  ds_read_b128 v[60:63], v45 offset:192
  ds_read_b128 v[64:67], v45 offset:256
  ds_read_b128 v[68:71], v45 offset:320
  ds_read_b128 v[72:75], v45 offset:384
  ds_read_b128 v[76:79], v45 offset:448
  v_mov_b32 v45, 139840
  ds_read_b32 v44, v45
  s_waitcnt lgkmcnt(0)
  v_readfirstlane_b32 s72, v44
  s_cmp_ge_u32 s3, 2
  s_cbranch_scc1 A_helper2
  s_cmp_eq_u32 s3, 0
  s_cselect_b32 s47, s38, 0x10000000
  s_mov_b32 s48, s47
  s_waitcnt vmcnt(40)
  v_mfma_f32_16x16x32_bf16 v[12:15], v[80:83], v[48:51], 0
  v_mfma_f32_16x16x32_bf16 v[12:15], v[84:87], v[52:55], v[12:15]
  v_mfma_f32_16x16x32_bf16 v[12:15], v[88:91], v[56:59], v[12:15]
  v_mfma_f32_16x16x32_bf16 v[12:15], v[92:95], v[60:63], v[12:15]
  v_mfma_f32_16x16x32_bf16 v[12:15], v[96:99], v[64:67], v[12:15]
  v_mfma_f32_16x16x32_bf16 v[12:15], v[100:103], v[68:71], v[12:15]
  v_mfma_f32_16x16x32_bf16 v[12:15], v[104:107], v[72:75], v[12:15]
  v_mfma_f32_16x16x32_bf16 v[12:15], v[108:111], v[76:79], v[12:15]
  s_and_b32 s49, s47, 0xfffff
  s_or_b32 s49, s49, s70
  s_cmp_ge_u32 s47, s71
  s_cselect_b32 s49, 0x10000000, s49
  buffer_load_dwordx4 v[80:83], v4, s[16:19], s49 offen offset:0 nt
  buffer_load_dwordx4 v[84:87], v4, s[16:19], s49 offen offset:64 nt
  buffer_load_dwordx4 v[88:91], v4, s[16:19], s49 offen offset:128 nt
  buffer_load_dwordx4 v[92:95], v4, s[16:19], s49 offen offset:192 nt
  buffer_load_dwordx4 v[96:99], v4, s[16:19], s49 offen offset:256 nt
  buffer_load_dwordx4 v[100:103], v4, s[16:19], s49 offen offset:320 nt
  buffer_load_dwordx4 v[104:107], v4, s[16:19], s49 offen offset:384 nt
  buffer_load_dwordx4 v[108:111], v4, s[16:19], s49 offen offset:448 nt
  s_add_u32 s47, s47, 8192
  s_nop 0
  v_cvt_pk_bf16_f32 v32, v12, v13
  v_cvt_pk_bf16_f32 v33, v14, v15
  v_lshlrev_b32 v28, 16, v32
  v_and_b32 v29, 0xffff0000, v32
  v_lshlrev_b32 v30, 16, v33
  v_and_b32 v31, 0xffff0000, v33
  v_max3_f32 v34, v28, v29, v30
  v_max_f32 v34, v34, v31
  v_cmp_gt_f32 vcc, v34, v24
  s_cmp_eq_u64 vcc, 0
  s_cbranch_scc1 A_nr0
  v_mov_b32 v35, v34
  s_nop 1
  v_permlane32_swap_b32 v34, v35
  v_max_f32 v34, v34, v35
  v_mov_b32 v35, v34
  s_nop 1
  v_permlane16_swap_b32 v34, v35
  v_max_f32 v34, v34, v35
  v_max_f32 v34, v34, v24
  v_sub_f32 v35, v24, v34
  v_mul_f32 v35, s45, v35
  v_exp_f32 v35, v35
  v_mov_b32 v24, v34
  v_mul_f32 v25, s45, v34
  v_mul_f32 v16, v16, v35
  v_mul_f32 v17, v17, v35
  v_mul_f32 v18, v18, v35
  v_mul_f32 v19, v19, v35
  v_mul_f32 v20, v20, v35
  v_mul_f32 v21, v21, v35
  v_mul_f32 v22, v22, v35
  v_mul_f32 v23, v23, v35
  v_mul_f32 v26, v26, v35
A_nr0:
  v_fma_f32 v28, v28, s45, -v25
  v_fma_f32 v29, v29, s45, -v25
  v_fma_f32 v30, v30, s45, -v25
  v_fma_f32 v31, v31, s45, -v25
  v_exp_f32 v28, v28
  v_exp_f32 v29, v29
  v_exp_f32 v30, v30
  v_exp_f32 v31, v31
  s_nop 0
  v_cvt_pk_bf16_f32 v32, v28, v28
  v_cvt_pk_bf16_f32 v33, v29, v29
  v_cvt_pk_bf16_f32 v34, v30, v30
  v_cvt_pk_bf16_f32 v35, v31, v31
  v_add_f32 v28, v28, v29
  v_add_f32 v30, v30, v31
  v_add_f32 v26, v26, v28
  v_add_f32 v26, v26, v30
  v_and_b32 v36, v32, v8
  v_and_b32 v37, v32, v9
  v_and_b32 v38, v32, v10
  v_and_b32 v39, v32, v11
  s_waitcnt vmcnt(40)
  s_nop 0
  v_mfma_f32_16x16x32_bf16 v[16:19], v[112:115], v[36:39], v[16:19]
  v_mfma_f32_16x16x32_bf16 v[20:23], v[116:119], v[36:39], v[20:23]
  v_and_b32 v40, v33, v8
  v_and_b32 v41, v33, v9
  v_and_b32 v42, v33, v10
  v_and_b32 v43, v33, v11
  s_nop 0
  s_nop 0
  v_mfma_f32_16x16x32_bf16 v[16:19], v[120:123], v[40:43], v[16:19]
  v_mfma_f32_16x16x32_bf16 v[20:23], v[124:127], v[40:43], v[20:23]
  v_and_b32 v36, v34, v8
  v_and_b32 v37, v34, v9
  v_and_b32 v38, v34, v10
  v_and_b32 v39, v34, v11
  s_nop 0
  s_nop 0
  v_mfma_f32_16x16x32_bf16 v[16:19], v[128:131], v[36:39], v[16:19]
  v_mfma_f32_16x16x32_bf16 v[20:23], v[132:135], v[36:39], v[20:23]
  v_and_b32 v40, v35, v8
  v_and_b32 v41, v35, v9
  v_and_b32 v42, v35, v10
  v_and_b32 v43, v35, v11
  s_nop 0
  s_nop 0
  v_mfma_f32_16x16x32_bf16 v[16:19], v[136:139], v[40:43], v[16:19]
  v_mfma_f32_16x16x32_bf16 v[20:23], v[140:143], v[40:43], v[20:23]
  s_and_b32 s49, s48, 0xfffff
  s_or_b32 s49, s49, s70
  s_cmp_ge_u32 s48, s71
  s_cselect_b32 s49, 0x10000000, s49
  buffer_load_dwordx4 v[112:115], v5, s[20:23], s49 offen offset:0 nt
  buffer_load_dwordx4 v[116:119], v5, s[20:23], s49 offen offset:256 nt
  buffer_load_dwordx4 v[120:123], v5, s[20:23], s49 offen offset:512 nt
  buffer_load_dwordx4 v[124:127], v5, s[20:23], s49 offen offset:768 nt
  buffer_load_dwordx4 v[128:131], v5, s[20:23], s49 offen offset:1024 nt
  buffer_load_dwordx4 v[132:135], v5, s[20:23], s49 offen offset:1280 nt
  buffer_load_dwordx4 v[136:139], v5, s[20:23], s49 offen offset:1536 nt
  buffer_load_dwordx4 v[140:143], v5, s[20:23], s49 offen offset:1792 nt
  s_add_u32 s48, s48, 8192
  v_mfma_f32_16x16x32_bf16 v[12:15], a[64:67], v[48:51], 0
  v_mfma_f32_16x16x32_bf16 v[12:15], a[68:71], v[52:55], v[12:15]
  v_mfma_f32_16x16x32_bf16 v[12:15], a[72:75], v[56:59], v[12:15]
  v_mfma_f32_16x16x32_bf16 v[12:15], a[76:79], v[60:63], v[12:15]
  v_mfma_f32_16x16x32_bf16 v[12:15], a[80:83], v[64:67], v[12:15]
  v_mfma_f32_16x16x32_bf16 v[12:15], a[84:87], v[68:71], v[12:15]
  v_mfma_f32_16x16x32_bf16 v[12:15], a[88:91], v[72:75], v[12:15]
  v_mfma_f32_16x16x32_bf16 v[12:15], a[92:95], v[76:79], v[12:15]
  s_nop 8
  v_cvt_pk_bf16_f32 v32, v12, v13
  v_cvt_pk_bf16_f32 v33, v14, v15
  v_lshlrev_b32 v28, 16, v32
  v_and_b32 v29, 0xffff0000, v32
  v_lshlrev_b32 v30, 16, v33
  v_and_b32 v31, 0xffff0000, v33
  v_max3_f32 v34, v28, v29, v30
  v_max_f32 v34, v34, v31
  v_cmp_gt_f32 vcc, v34, v24
  s_cmp_eq_u64 vcc, 0
  s_cbranch_scc1 A_nr1
  v_mov_b32 v35, v34
  s_nop 1
  v_permlane32_swap_b32 v34, v35
  v_max_f32 v34, v34, v35
  v_mov_b32 v35, v34
  s_nop 1
  v_permlane16_swap_b32 v34, v35
  v_max_f32 v34, v34, v35
  v_max_f32 v34, v34, v24
  v_sub_f32 v35, v24, v34
  v_mul_f32 v35, s45, v35
  v_exp_f32 v35, v35
  v_mov_b32 v24, v34
  v_mul_f32 v25, s45, v34
  v_mul_f32 v16, v16, v35
  v_mul_f32 v17, v17, v35
  v_mul_f32 v18, v18, v35
  v_mul_f32 v19, v19, v35
  v_mul_f32 v20, v20, v35
  v_mul_f32 v21, v21, v35
  v_mul_f32 v22, v22, v35
  v_mul_f32 v23, v23, v35
  v_mul_f32 v26, v26, v35
A_nr1:
  v_fma_f32 v28, v28, s45, -v25
  v_fma_f32 v29, v29, s45, -v25
  v_fma_f32 v30, v30, s45, -v25
  v_fma_f32 v31, v31, s45, -v25
  v_exp_f32 v28, v28
  v_exp_f32 v29, v29
  v_exp_f32 v30, v30
  v_exp_f32 v31, v31
  s_nop 0
  v_cvt_pk_bf16_f32 v32, v28, v28
  v_cvt_pk_bf16_f32 v33, v29, v29
  v_cvt_pk_bf16_f32 v34, v30, v30
  v_cvt_pk_bf16_f32 v35, v31, v31
  v_add_f32 v28, v28, v29
  v_add_f32 v30, v30, v31
  v_add_f32 v26, v26, v28
  v_add_f32 v26, v26, v30
  v_and_b32 v36, v32, v8
  v_and_b32 v37, v32, v9
  v_and_b32 v38, v32, v10
  v_and_b32 v39, v32, v11
  s_nop 0
  s_nop 0
  v_mfma_f32_16x16x32_bf16 v[16:19], a[96:99], v[36:39], v[16:19]
  v_mfma_f32_16x16x32_bf16 v[20:23], a[100:103], v[36:39], v[20:23]
  v_and_b32 v40, v33, v8
  v_and_b32 v41, v33, v9
  v_and_b32 v42, v33, v10
  v_and_b32 v43, v33, v11
  s_nop 0
  s_nop 0
  v_mfma_f32_16x16x32_bf16 v[16:19], a[104:107], v[40:43], v[16:19]
  v_mfma_f32_16x16x32_bf16 v[20:23], a[108:111], v[40:43], v[20:23]
  v_and_b32 v36, v34, v8
  v_and_b32 v37, v34, v9
  v_and_b32 v38, v34, v10
  v_and_b32 v39, v34, v11
  s_nop 0
  s_nop 0
  v_mfma_f32_16x16x32_bf16 v[16:19], a[112:115], v[36:39], v[16:19]
  v_mfma_f32_16x16x32_bf16 v[20:23], a[116:119], v[36:39], v[20:23]
  v_and_b32 v40, v35, v8
  v_and_b32 v41, v35, v9
  v_and_b32 v42, v35, v10
  v_and_b32 v43, v35, v11
  s_nop 0
  s_nop 0
  v_mfma_f32_16x16x32_bf16 v[16:19], a[120:123], v[40:43], v[16:19]
  v_mfma_f32_16x16x32_bf16 v[20:23], a[124:127], v[40:43], v[20:23]
  s_waitcnt vmcnt(40)
  v_mfma_f32_16x16x32_bf16 v[12:15], v[144:147], v[48:51], 0
  v_mfma_f32_16x16x32_bf16 v[12:15], v[148:151], v[52:55], v[12:15]
  v_mfma_f32_16x16x32_bf16 v[12:15], v[152:155], v[56:59], v[12:15]
  v_mfma_f32_16x16x32_bf16 v[12:15], v[156:159], v[60:63], v[12:15]
  v_mfma_f32_16x16x32_bf16 v[12:15], v[160:163], v[64:67], v[12:15]
  v_mfma_f32_16x16x32_bf16 v[12:15], v[164:167], v[68:71], v[12:15]
  v_mfma_f32_16x16x32_bf16 v[12:15], v[168:171], v[72:75], v[12:15]
  v_mfma_f32_16x16x32_bf16 v[12:15], v[172:175], v[76:79], v[12:15]
  s_and_b32 s49, s47, 0xfffff
  s_or_b32 s49, s49, s70
  s_cmp_ge_u32 s47, s71
  s_cselect_b32 s49, 0x10000000, s49
  buffer_load_dwordx4 v[144:147], v4, s[16:19], s49 offen offset:0 nt
  buffer_load_dwordx4 v[148:151], v4, s[16:19], s49 offen offset:64 nt
  buffer_load_dwordx4 v[152:155], v4, s[16:19], s49 offen offset:128 nt
  buffer_load_dwordx4 v[156:159], v4, s[16:19], s49 offen offset:192 nt
  buffer_load_dwordx4 v[160:163], v4, s[16:19], s49 offen offset:256 nt
  buffer_load_dwordx4 v[164:167], v4, s[16:19], s49 offen offset:320 nt
  buffer_load_dwordx4 v[168:171], v4, s[16:19], s49 offen offset:384 nt
  buffer_load_dwordx4 v[172:175], v4, s[16:19], s49 offen offset:448 nt
  s_add_u32 s47, s47, 8192
  s_nop 0
  v_cvt_pk_bf16_f32 v32, v12, v13
  v_cvt_pk_bf16_f32 v33, v14, v15
  v_lshlrev_b32 v28, 16, v32
  v_and_b32 v29, 0xffff0000, v32
  v_lshlrev_b32 v30, 16, v33
  v_and_b32 v31, 0xffff0000, v33
  v_max3_f32 v34, v28, v29, v30
  v_max_f32 v34, v34, v31
  v_cmp_gt_f32 vcc, v34, v24
  s_cmp_eq_u64 vcc, 0
  s_cbranch_scc1 A_nr2
  v_mov_b32 v35, v34
  s_nop 1
  v_permlane32_swap_b32 v34, v35
  v_max_f32 v34, v34, v35
  v_mov_b32 v35, v34
  s_nop 1
  v_permlane16_swap_b32 v34, v35
  v_max_f32 v34, v34, v35
  v_max_f32 v34, v34, v24
  v_sub_f32 v35, v24, v34
  v_mul_f32 v35, s45, v35
  v_exp_f32 v35, v35
  v_mov_b32 v24, v34
  v_mul_f32 v25, s45, v34
  v_mul_f32 v16, v16, v35
  v_mul_f32 v17, v17, v35
  v_mul_f32 v18, v18, v35
  v_mul_f32 v19, v19, v35
  v_mul_f32 v20, v20, v35
  v_mul_f32 v21, v21, v35
  v_mul_f32 v22, v22, v35
  v_mul_f32 v23, v23, v35
  v_mul_f32 v26, v26, v35
A_nr2:
  v_fma_f32 v28, v28, s45, -v25
  v_fma_f32 v29, v29, s45, -v25
  v_fma_f32 v30, v30, s45, -v25
  v_fma_f32 v31, v31, s45, -v25
  v_exp_f32 v28, v28
  v_exp_f32 v29, v29
  v_exp_f32 v30, v30
  v_exp_f32 v31, v31
  s_nop 0
  v_cvt_pk_bf16_f32 v32, v28, v28
  v_cvt_pk_bf16_f32 v33, v29, v29
  v_cvt_pk_bf16_f32 v34, v30, v30
  v_cvt_pk_bf16_f32 v35, v31, v31
  v_add_f32 v28, v28, v29
  v_add_f32 v30, v30, v31
  v_add_f32 v26, v26, v28
  v_add_f32 v26, v26, v30
  v_and_b32 v36, v32, v8
  v_and_b32 v37, v32, v9
  v_and_b32 v38, v32, v10
  v_and_b32 v39, v32, v11
  s_waitcnt vmcnt(40)
  s_nop 0
  v_mfma_f32_16x16x32_bf16 v[16:19], v[176:179], v[36:39], v[16:19]
  v_mfma_f32_16x16x32_bf16 v[20:23], v[180:183], v[36:39], v[20:23]
  v_and_b32 v40, v33, v8
  v_and_b32 v41, v33, v9
  v_and_b32 v42, v33, v10
  v_and_b32 v43, v33, v11
  s_nop 0
  s_nop 0
  v_mfma_f32_16x16x32_bf16 v[16:19], v[184:187], v[40:43], v[16:19]
  v_mfma_f32_16x16x32_bf16 v[20:23], v[188:191], v[40:43], v[20:23]
  v_and_b32 v36, v34, v8
  v_and_b32 v37, v34, v9
  v_and_b32 v38, v34, v10
  v_and_b32 v39, v34, v11
  s_nop 0
  s_nop 0
  v_mfma_f32_16x16x32_bf16 v[16:19], v[192:195], v[36:39], v[16:19]
  v_mfma_f32_16x16x32_bf16 v[20:23], v[196:199], v[36:39], v[20:23]
  v_and_b32 v40, v35, v8
  v_and_b32 v41, v35, v9
  v_and_b32 v42, v35, v10
  v_and_b32 v43, v35, v11
  s_nop 0
  s_nop 0
  v_mfma_f32_16x16x32_bf16 v[16:19], v[200:203], v[40:43], v[16:19]
  v_mfma_f32_16x16x32_bf16 v[20:23], v[204:207], v[40:43], v[20:23]
  s_and_b32 s49, s48, 0xfffff
  s_or_b32 s49, s49, s70
  s_cmp_ge_u32 s48, s71
  s_cselect_b32 s49, 0x10000000, s49
  buffer_load_dwordx4 v[176:179], v5, s[20:23], s49 offen offset:0 nt
  buffer_load_dwordx4 v[180:183], v5, s[20:23], s49 offen offset:256 nt
  buffer_load_dwordx4 v[184:187], v5, s[20:23], s49 offen offset:512 nt
  buffer_load_dwordx4 v[188:191], v5, s[20:23], s49 offen offset:768 nt
  buffer_load_dwordx4 v[192:195], v5, s[20:23], s49 offen offset:1024 nt
  buffer_load_dwordx4 v[196:199], v5, s[20:23], s49 offen offset:1280 nt
  buffer_load_dwordx4 v[200:203], v5, s[20:23], s49 offen offset:1536 nt
  buffer_load_dwordx4 v[204:207], v5, s[20:23], s49 offen offset:1792 nt
  s_add_u32 s48, s48, 8192
  v_mfma_f32_16x16x32_bf16 v[12:15], a[128:131], v[48:51], 0
  v_mfma_f32_16x16x32_bf16 v[12:15], a[132:135], v[52:55], v[12:15]
  v_mfma_f32_16x16x32_bf16 v[12:15], a[136:139], v[56:59], v[12:15]
  v_mfma_f32_16x16x32_bf16 v[12:15], a[140:143], v[60:63], v[12:15]
  v_mfma_f32_16x16x32_bf16 v[12:15], a[144:147], v[64:67], v[12:15]
  v_mfma_f32_16x16x32_bf16 v[12:15], a[148:151], v[68:71], v[12:15]
  v_mfma_f32_16x16x32_bf16 v[12:15], a[152:155], v[72:75], v[12:15]
  v_mfma_f32_16x16x32_bf16 v[12:15], a[156:159], v[76:79], v[12:15]
  s_nop 8
  v_cvt_pk_bf16_f32 v32, v12, v13
  v_cvt_pk_bf16_f32 v33, v14, v15
  v_lshlrev_b32 v28, 16, v32
  v_and_b32 v29, 0xffff0000, v32
  v_lshlrev_b32 v30, 16, v33
  v_and_b32 v31, 0xffff0000, v33
  v_max3_f32 v34, v28, v29, v30
  v_max_f32 v34, v34, v31
  v_cmp_gt_f32 vcc, v34, v24
  s_cmp_eq_u64 vcc, 0
  s_cbranch_scc1 A_nr3
  v_mov_b32 v35, v34
  s_nop 1
  v_permlane32_swap_b32 v34, v35
  v_max_f32 v34, v34, v35
  v_mov_b32 v35, v34
  s_nop 1
  v_permlane16_swap_b32 v34, v35
  v_max_f32 v34, v34, v35
  v_max_f32 v34, v34, v24
  v_sub_f32 v35, v24, v34
  v_mul_f32 v35, s45, v35
  v_exp_f32 v35, v35
  v_mov_b32 v24, v34
  v_mul_f32 v25, s45, v34
  v_mul_f32 v16, v16, v35
  v_mul_f32 v17, v17, v35
  v_mul_f32 v18, v18, v35
  v_mul_f32 v19, v19, v35
  v_mul_f32 v20, v20, v35
  v_mul_f32 v21, v21, v35
  v_mul_f32 v22, v22, v35
  v_mul_f32 v23, v23, v35
  v_mul_f32 v26, v26, v35
A_nr3:
  v_fma_f32 v28, v28, s45, -v25
  v_fma_f32 v29, v29, s45, -v25
  v_fma_f32 v30, v30, s45, -v25
  v_fma_f32 v31, v31, s45, -v25
  v_exp_f32 v28, v28
  v_exp_f32 v29, v29
  v_exp_f32 v30, v30
  v_exp_f32 v31, v31
  s_nop 0
  v_cvt_pk_bf16_f32 v32, v28, v28
  v_cvt_pk_bf16_f32 v33, v29, v29
  v_cvt_pk_bf16_f32 v34, v30, v30
  v_cvt_pk_bf16_f32 v35, v31, v31
  v_add_f32 v28, v28, v29
  v_add_f32 v30, v30, v31
  v_add_f32 v26, v26, v28
  v_add_f32 v26, v26, v30
  v_and_b32 v36, v32, v8
  v_and_b32 v37, v32, v9
  v_and_b32 v38, v32, v10
  v_and_b32 v39, v32, v11
  s_nop 0
  s_nop 0
  v_mfma_f32_16x16x32_bf16 v[16:19], a[160:163], v[36:39], v[16:19]
  v_mfma_f32_16x16x32_bf16 v[20:23], a[164:167], v[36:39], v[20:23]
  v_and_b32 v40, v33, v8
  v_and_b32 v41, v33, v9
  v_and_b32 v42, v33, v10
  v_and_b32 v43, v33, v11
  s_nop 0
  s_nop 0
  v_mfma_f32_16x16x32_bf16 v[16:19], a[168:171], v[40:43], v[16:19]
  v_mfma_f32_16x16x32_bf16 v[20:23], a[172:175], v[40:43], v[20:23]
  v_and_b32 v36, v34, v8
  v_and_b32 v37, v34, v9
  v_and_b32 v38, v34, v10
  v_and_b32 v39, v34, v11
  s_nop 0
  s_nop 0
  v_mfma_f32_16x16x32_bf16 v[16:19], a[176:179], v[36:39], v[16:19]
  v_mfma_f32_16x16x32_bf16 v[20:23], a[180:183], v[36:39], v[20:23]
  v_and_b32 v40, v35, v8
  v_and_b32 v41, v35, v9
  v_and_b32 v42, v35, v10
  v_and_b32 v43, v35, v11
  s_nop 0
  s_nop 0
  v_mfma_f32_16x16x32_bf16 v[16:19], a[184:187], v[40:43], v[16:19]
  v_mfma_f32_16x16x32_bf16 v[20:23], a[188:191], v[40:43], v[20:23]
  s_waitcnt vmcnt(40)
  v_mfma_f32_16x16x32_bf16 v[12:15], a[0:3], v[48:51], 0
  v_mfma_f32_16x16x32_bf16 v[12:15], a[4:7], v[52:55], v[12:15]
  v_mfma_f32_16x16x32_bf16 v[12:15], a[8:11], v[56:59], v[12:15]
  v_mfma_f32_16x16x32_bf16 v[12:15], a[12:15], v[60:63], v[12:15]
  v_mfma_f32_16x16x32_bf16 v[12:15], a[16:19], v[64:67], v[12:15]
  v_mfma_f32_16x16x32_bf16 v[12:15], a[20:23], v[68:71], v[12:15]
  v_mfma_f32_16x16x32_bf16 v[12:15], a[24:27], v[72:75], v[12:15]
  v_mfma_f32_16x16x32_bf16 v[12:15], a[28:31], v[76:79], v[12:15]
  s_and_b32 s49, s47, 0xfffff
  s_or_b32 s49, s49, s70
  s_cmp_ge_u32 s47, s71
  s_cselect_b32 s49, 0x10000000, s49
  buffer_load_dwordx4 a[0:3], v4, s[16:19], s49 offen offset:0 nt
  buffer_load_dwordx4 a[4:7], v4, s[16:19], s49 offen offset:64 nt
  buffer_load_dwordx4 a[8:11], v4, s[16:19], s49 offen offset:128 nt
  buffer_load_dwordx4 a[12:15], v4, s[16:19], s49 offen offset:192 nt
  buffer_load_dwordx4 a[16:19], v4, s[16:19], s49 offen offset:256 nt
  buffer_load_dwordx4 a[20:23], v4, s[16:19], s49 offen offset:320 nt
  buffer_load_dwordx4 a[24:27], v4, s[16:19], s49 offen offset:384 nt
  buffer_load_dwordx4 a[28:31], v4, s[16:19], s49 offen offset:448 nt
  s_add_u32 s47, s47, 8192
  s_nop 0
  v_cvt_pk_bf16_f32 v32, v12, v13
  v_cvt_pk_bf16_f32 v33, v14, v15
  v_lshlrev_b32 v28, 16, v32
  v_and_b32 v29, 0xffff0000, v32
  v_lshlrev_b32 v30, 16, v33
  v_and_b32 v31, 0xffff0000, v33
  v_max3_f32 v34, v28, v29, v30
  v_max_f32 v34, v34, v31
  v_cmp_gt_f32 vcc, v34, v24
  s_cmp_eq_u64 vcc, 0
  s_cbranch_scc1 A_nr4
  v_mov_b32 v35, v34
  s_nop 1
  v_permlane32_swap_b32 v34, v35
  v_max_f32 v34, v34, v35
  v_mov_b32 v35, v34
  s_nop 1
  v_permlane16_swap_b32 v34, v35
  v_max_f32 v34, v34, v35
  v_max_f32 v34, v34, v24
  v_sub_f32 v35, v24, v34
  v_mul_f32 v35, s45, v35
  v_exp_f32 v35, v35
  v_mov_b32 v24, v34
  v_mul_f32 v25, s45, v34
  v_mul_f32 v16, v16, v35
  v_mul_f32 v17, v17, v35
  v_mul_f32 v18, v18, v35
  v_mul_f32 v19, v19, v35
  v_mul_f32 v20, v20, v35
  v_mul_f32 v21, v21, v35
  v_mul_f32 v22, v22, v35
  v_mul_f32 v23, v23, v35
  v_mul_f32 v26, v26, v35
A_nr4:
  v_fma_f32 v28, v28, s45, -v25
  v_fma_f32 v29, v29, s45, -v25
  v_fma_f32 v30, v30, s45, -v25
  v_fma_f32 v31, v31, s45, -v25
  v_exp_f32 v28, v28
  v_exp_f32 v29, v29
  v_exp_f32 v30, v30
  v_exp_f32 v31, v31
  s_nop 0
  v_cvt_pk_bf16_f32 v32, v28, v28
  v_cvt_pk_bf16_f32 v33, v29, v29
  v_cvt_pk_bf16_f32 v34, v30, v30
  v_cvt_pk_bf16_f32 v35, v31, v31
  v_add_f32 v28, v28, v29
  v_add_f32 v30, v30, v31
  v_add_f32 v26, v26, v28
  v_add_f32 v26, v26, v30
  v_and_b32 v36, v32, v8
  v_and_b32 v37, v32, v9
  v_and_b32 v38, v32, v10
  v_and_b32 v39, v32, v11
  s_waitcnt vmcnt(40)
  s_nop 0
  v_mfma_f32_16x16x32_bf16 v[16:19], a[32:35], v[36:39], v[16:19]
  v_mfma_f32_16x16x32_bf16 v[20:23], a[36:39], v[36:39], v[20:23]
  v_and_b32 v40, v33, v8
  v_and_b32 v41, v33, v9
  v_and_b32 v42, v33, v10
  v_and_b32 v43, v33, v11
  s_nop 0
  s_nop 0
  v_mfma_f32_16x16x32_bf16 v[16:19], a[40:43], v[40:43], v[16:19]
  v_mfma_f32_16x16x32_bf16 v[20:23], a[44:47], v[40:43], v[20:23]
  v_and_b32 v36, v34, v8
  v_and_b32 v37, v34, v9
  v_and_b32 v38, v34, v10
  v_and_b32 v39, v34, v11
  s_nop 0
  s_nop 0
  v_mfma_f32_16x16x32_bf16 v[16:19], a[48:51], v[36:39], v[16:19]
  v_mfma_f32_16x16x32_bf16 v[20:23], a[52:55], v[36:39], v[20:23]
  v_and_b32 v40, v35, v8
  v_and_b32 v41, v35, v9
  v_and_b32 v42, v35, v10
  v_and_b32 v43, v35, v11
  s_nop 0
  s_nop 0
  v_mfma_f32_16x16x32_bf16 v[16:19], a[56:59], v[40:43], v[16:19]
  v_mfma_f32_16x16x32_bf16 v[20:23], a[60:63], v[40:43], v[20:23]
  s_and_b32 s49, s48, 0xfffff
  s_or_b32 s49, s49, s70
  s_cmp_ge_u32 s48, s71
  s_cselect_b32 s49, 0x10000000, s49
  buffer_load_dwordx4 a[32:35], v5, s[20:23], s49 offen offset:0 nt
  buffer_load_dwordx4 a[36:39], v5, s[20:23], s49 offen offset:256 nt
  buffer_load_dwordx4 a[40:43], v5, s[20:23], s49 offen offset:512 nt
  buffer_load_dwordx4 a[44:47], v5, s[20:23], s49 offen offset:768 nt
  buffer_load_dwordx4 a[48:51], v5, s[20:23], s49 offen offset:1024 nt
  buffer_load_dwordx4 a[52:55], v5, s[20:23], s49 offen offset:1280 nt
  buffer_load_dwordx4 a[56:59], v5, s[20:23], s49 offen offset:1536 nt
  buffer_load_dwordx4 a[60:63], v5, s[20:23], s49 offen offset:1792 nt
  s_add_u32 s48, s48, 8192
  v_mfma_f32_16x16x32_bf16 v[12:15], a[192:195], v[48:51], 0
  v_mfma_f32_16x16x32_bf16 v[12:15], a[196:199], v[52:55], v[12:15]
  v_mfma_f32_16x16x32_bf16 v[12:15], a[200:203], v[56:59], v[12:15]
  v_mfma_f32_16x16x32_bf16 v[12:15], a[204:207], v[60:63], v[12:15]
  v_mfma_f32_16x16x32_bf16 v[12:15], a[208:211], v[64:67], v[12:15]
  v_mfma_f32_16x16x32_bf16 v[12:15], a[212:215], v[68:71], v[12:15]
  v_mfma_f32_16x16x32_bf16 v[12:15], a[216:219], v[72:75], v[12:15]
  v_mfma_f32_16x16x32_bf16 v[12:15], a[220:223], v[76:79], v[12:15]
  s_nop 8
  v_cvt_pk_bf16_f32 v32, v12, v13
  v_cvt_pk_bf16_f32 v33, v14, v15
  v_lshlrev_b32 v28, 16, v32
  v_and_b32 v29, 0xffff0000, v32
  v_lshlrev_b32 v30, 16, v33
  v_and_b32 v31, 0xffff0000, v33
  v_max3_f32 v34, v28, v29, v30
  v_max_f32 v34, v34, v31
  v_cmp_gt_f32 vcc, v34, v24
  s_cmp_eq_u64 vcc, 0
  s_cbranch_scc1 A_nr5
  v_mov_b32 v35, v34
  s_nop 1
  v_permlane32_swap_b32 v34, v35
  v_max_f32 v34, v34, v35
  v_mov_b32 v35, v34
  s_nop 1
  v_permlane16_swap_b32 v34, v35
  v_max_f32 v34, v34, v35
  v_max_f32 v34, v34, v24
  v_sub_f32 v35, v24, v34
  v_mul_f32 v35, s45, v35
  v_exp_f32 v35, v35
  v_mov_b32 v24, v34
  v_mul_f32 v25, s45, v34
  v_mul_f32 v16, v16, v35
  v_mul_f32 v17, v17, v35
  v_mul_f32 v18, v18, v35
  v_mul_f32 v19, v19, v35
  v_mul_f32 v20, v20, v35
  v_mul_f32 v21, v21, v35
  v_mul_f32 v22, v22, v35
  v_mul_f32 v23, v23, v35
  v_mul_f32 v26, v26, v35
A_nr5:
  v_fma_f32 v28, v28, s45, -v25
  v_fma_f32 v29, v29, s45, -v25
  v_fma_f32 v30, v30, s45, -v25
  v_fma_f32 v31, v31, s45, -v25
  v_exp_f32 v28, v28
  v_exp_f32 v29, v29
  v_exp_f32 v30, v30
  v_exp_f32 v31, v31
  s_nop 0
  v_cvt_pk_bf16_f32 v32, v28, v28
  v_cvt_pk_bf16_f32 v33, v29, v29
  v_cvt_pk_bf16_f32 v34, v30, v30
  v_cvt_pk_bf16_f32 v35, v31, v31
  v_add_f32 v28, v28, v29
  v_add_f32 v30, v30, v31
  v_add_f32 v26, v26, v28
  v_add_f32 v26, v26, v30
  v_and_b32 v36, v32, v8
  v_and_b32 v37, v32, v9
  v_and_b32 v38, v32, v10
  v_and_b32 v39, v32, v11
  s_nop 0
  s_nop 0
  v_mfma_f32_16x16x32_bf16 v[16:19], a[224:227], v[36:39], v[16:19]
  v_mfma_f32_16x16x32_bf16 v[20:23], a[228:231], v[36:39], v[20:23]
  v_and_b32 v40, v33, v8
  v_and_b32 v41, v33, v9
  v_and_b32 v42, v33, v10
  v_and_b32 v43, v33, v11
  s_nop 0
  s_nop 0
  v_mfma_f32_16x16x32_bf16 v[16:19], a[232:235], v[40:43], v[16:19]
  v_mfma_f32_16x16x32_bf16 v[20:23], a[236:239], v[40:43], v[20:23]
  v_and_b32 v36, v34, v8
  v_and_b32 v37, v34, v9
  v_and_b32 v38, v34, v10
  v_and_b32 v39, v34, v11
  s_nop 0
  s_nop 0
  v_mfma_f32_16x16x32_bf16 v[16:19], a[240:243], v[36:39], v[16:19]
  v_mfma_f32_16x16x32_bf16 v[20:23], a[244:247], v[36:39], v[20:23]
  v_and_b32 v40, v35, v8
  v_and_b32 v41, v35, v9
  v_and_b32 v42, v35, v10
  v_and_b32 v43, v35, v11
  s_nop 0
  s_nop 0
  v_mfma_f32_16x16x32_bf16 v[16:19], a[248:251], v[40:43], v[16:19]
  v_mfma_f32_16x16x32_bf16 v[20:23], a[252:255], v[40:43], v[20:23]
  s_cmp_lg_u32 s3, 0
  s_cbranch_scc1 A_w1done
  s_mov_b32 s46, 36
A_loop:
  s_waitcnt vmcnt(40)
  v_mfma_f32_16x16x32_bf16 v[12:15], v[80:83], v[48:51], 0
  v_mfma_f32_16x16x32_bf16 v[12:15], v[84:87], v[52:55], v[12:15]
  v_mfma_f32_16x16x32_bf16 v[12:15], v[88:91], v[56:59], v[12:15]
  v_mfma_f32_16x16x32_bf16 v[12:15], v[92:95], v[60:63], v[12:15]
  v_mfma_f32_16x16x32_bf16 v[12:15], v[96:99], v[64:67], v[12:15]
  v_mfma_f32_16x16x32_bf16 v[12:15], v[100:103], v[68:71], v[12:15]
  v_mfma_f32_16x16x32_bf16 v[12:15], v[104:107], v[72:75], v[12:15]
  v_mfma_f32_16x16x32_bf16 v[12:15], v[108:111], v[76:79], v[12:15]
  s_and_b32 s49, s47, 0xfffff
  s_or_b32 s49, s49, s70
  s_cmp_ge_u32 s47, s71
  s_cselect_b32 s49, 0x10000000, s49
  buffer_load_dwordx4 v[80:83], v4, s[16:19], s49 offen offset:0 nt
  buffer_load_dwordx4 v[84:87], v4, s[16:19], s49 offen offset:64 nt
  buffer_load_dwordx4 v[88:91], v4, s[16:19], s49 offen offset:128 nt
  buffer_load_dwordx4 v[92:95], v4, s[16:19], s49 offen offset:192 nt
  buffer_load_dwordx4 v[96:99], v4, s[16:19], s49 offen offset:256 nt
  buffer_load_dwordx4 v[100:103], v4, s[16:19], s49 offen offset:320 nt
  buffer_load_dwordx4 v[104:107], v4, s[16:19], s49 offen offset:384 nt
  buffer_load_dwordx4 v[108:111], v4, s[16:19], s49 offen offset:448 nt
  s_add_u32 s47, s47, 8192
  s_nop 0
  v_cvt_pk_bf16_f32 v32, v12, v13
  v_cvt_pk_bf16_f32 v33, v14, v15
  v_lshlrev_b32 v28, 16, v32
  v_and_b32 v29, 0xffff0000, v32
  v_lshlrev_b32 v30, 16, v33
  v_and_b32 v31, 0xffff0000, v33
  v_max3_f32 v34, v28, v29, v30
  v_max_f32 v34, v34, v31
  v_cmp_gt_f32 vcc, v34, v24
  s_cmp_eq_u64 vcc, 0
  s_cbranch_scc1 A_nr6
  v_mov_b32 v35, v34
  s_nop 1
  v_permlane32_swap_b32 v34, v35
  v_max_f32 v34, v34, v35
  v_mov_b32 v35, v34
  s_nop 1
  v_permlane16_swap_b32 v34, v35
  v_max_f32 v34, v34, v35
  v_max_f32 v34, v34, v24
  v_sub_f32 v35, v24, v34
  v_mul_f32 v35, s45, v35
  v_exp_f32 v35, v35
  v_mov_b32 v24, v34
  v_mul_f32 v25, s45, v34
  v_mul_f32 v16, v16, v35
  v_mul_f32 v17, v17, v35
  v_mul_f32 v18, v18, v35
  v_mul_f32 v19, v19, v35
  v_mul_f32 v20, v20, v35
  v_mul_f32 v21, v21, v35
  v_mul_f32 v22, v22, v35
  v_mul_f32 v23, v23, v35
  v_mul_f32 v26, v26, v35
A_nr6:
  v_fma_f32 v28, v28, s45, -v25
  v_fma_f32 v29, v29, s45, -v25
  v_fma_f32 v30, v30, s45, -v25
  v_fma_f32 v31, v31, s45, -v25
  v_exp_f32 v28, v28
  v_exp_f32 v29, v29
  v_exp_f32 v30, v30
  v_exp_f32 v31, v31
  s_nop 0
  v_cvt_pk_bf16_f32 v32, v28, v28
  v_cvt_pk_bf16_f32 v33, v29, v29
  v_cvt_pk_bf16_f32 v34, v30, v30
  v_cvt_pk_bf16_f32 v35, v31, v31
  v_add_f32 v28, v28, v29
  v_add_f32 v30, v30, v31
  v_add_f32 v26, v26, v28
  v_add_f32 v26, v26, v30
  v_and_b32 v36, v32, v8
  v_and_b32 v37, v32, v9
  v_and_b32 v38, v32, v10
  v_and_b32 v39, v32, v11
  s_waitcnt vmcnt(40)
  s_nop 0
  v_mfma_f32_16x16x32_bf16 v[16:19], v[112:115], v[36:39], v[16:19]
  v_mfma_f32_16x16x32_bf16 v[20:23], v[116:119], v[36:39], v[20:23]
  v_and_b32 v40, v33, v8
  v_and_b32 v41, v33, v9
  v_and_b32 v42, v33, v10
  v_and_b32 v43, v33, v11
  s_nop 0
  s_nop 0
  v_mfma_f32_16x16x32_bf16 v[16:19], v[120:123], v[40:43], v[16:19]
  v_mfma_f32_16x16x32_bf16 v[20:23], v[124:127], v[40:43], v[20:23]
  v_and_b32 v36, v34, v8
  v_and_b32 v37, v34, v9
  v_and_b32 v38, v34, v10
  v_and_b32 v39, v34, v11
  s_nop 0
  s_nop 0
  v_mfma_f32_16x16x32_bf16 v[16:19], v[128:131], v[36:39], v[16:19]
  v_mfma_f32_16x16x32_bf16 v[20:23], v[132:135], v[36:39], v[20:23]
  v_and_b32 v40, v35, v8
  v_and_b32 v41, v35, v9
  v_and_b32 v42, v35, v10
  v_and_b32 v43, v35, v11
  s_nop 0
  s_nop 0
  v_mfma_f32_16x16x32_bf16 v[16:19], v[136:139], v[40:43], v[16:19]
  v_mfma_f32_16x16x32_bf16 v[20:23], v[140:143], v[40:43], v[20:23]
  s_and_b32 s49, s48, 0xfffff
  s_or_b32 s49, s49, s70
  s_cmp_ge_u32 s48, s71
  s_cselect_b32 s49, 0x10000000, s49
  buffer_load_dwordx4 v[112:115], v5, s[20:23], s49 offen offset:0 nt
  buffer_load_dwordx4 v[116:119], v5, s[20:23], s49 offen offset:256 nt
  buffer_load_dwordx4 v[120:123], v5, s[20:23], s49 offen offset:512 nt
  buffer_load_dwordx4 v[124:127], v5, s[20:23], s49 offen offset:768 nt
  buffer_load_dwordx4 v[128:131], v5, s[20:23], s49 offen offset:1024 nt
  buffer_load_dwordx4 v[132:135], v5, s[20:23], s49 offen offset:1280 nt
  buffer_load_dwordx4 v[136:139], v5, s[20:23], s49 offen offset:1536 nt
  buffer_load_dwordx4 v[140:143], v5, s[20:23], s49 offen offset:1792 nt
  s_add_u32 s48, s48, 8192
  s_waitcnt vmcnt(40)
  v_mfma_f32_16x16x32_bf16 v[12:15], v[144:147], v[48:51], 0
  v_mfma_f32_16x16x32_bf16 v[12:15], v[148:151], v[52:55], v[12:15]
  v_mfma_f32_16x16x32_bf16 v[12:15], v[152:155], v[56:59], v[12:15]
  v_mfma_f32_16x16x32_bf16 v[12:15], v[156:159], v[60:63], v[12:15]
  v_mfma_f32_16x16x32_bf16 v[12:15], v[160:163], v[64:67], v[12:15]
  v_mfma_f32_16x16x32_bf16 v[12:15], v[164:167], v[68:71], v[12:15]
  v_mfma_f32_16x16x32_bf16 v[12:15], v[168:171], v[72:75], v[12:15]
  v_mfma_f32_16x16x32_bf16 v[12:15], v[172:175], v[76:79], v[12:15]
  s_and_b32 s49, s47, 0xfffff
  s_or_b32 s49, s49, s70
  s_cmp_ge_u32 s47, s71
  s_cselect_b32 s49, 0x10000000, s49
  buffer_load_dwordx4 v[144:147], v4, s[16:19], s49 offen offset:0 nt
  buffer_load_dwordx4 v[148:151], v4, s[16:19], s49 offen offset:64 nt
  buffer_load_dwordx4 v[152:155], v4, s[16:19], s49 offen offset:128 nt
  buffer_load_dwordx4 v[156:159], v4, s[16:19], s49 offen offset:192 nt
  buffer_load_dwordx4 v[160:163], v4, s[16:19], s49 offen offset:256 nt
  buffer_load_dwordx4 v[164:167], v4, s[16:19], s49 offen offset:320 nt
  buffer_load_dwordx4 v[168:171], v4, s[16:19], s49 offen offset:384 nt
  buffer_load_dwordx4 v[172:175], v4, s[16:19], s49 offen offset:448 nt
  s_add_u32 s47, s47, 8192
  s_nop 0
  v_cvt_pk_bf16_f32 v32, v12, v13
  v_cvt_pk_bf16_f32 v33, v14, v15
  v_lshlrev_b32 v28, 16, v32
  v_and_b32 v29, 0xffff0000, v32
  v_lshlrev_b32 v30, 16, v33
  v_and_b32 v31, 0xffff0000, v33
  v_max3_f32 v34, v28, v29, v30
  v_max_f32 v34, v34, v31
  v_cmp_gt_f32 vcc, v34, v24
  s_cmp_eq_u64 vcc, 0
  s_cbranch_scc1 A_nr7
  v_mov_b32 v35, v34
  s_nop 1
  v_permlane32_swap_b32 v34, v35
  v_max_f32 v34, v34, v35
  v_mov_b32 v35, v34
  s_nop 1
  v_permlane16_swap_b32 v34, v35
  v_max_f32 v34, v34, v35
  v_max_f32 v34, v34, v24
  v_sub_f32 v35, v24, v34
  v_mul_f32 v35, s45, v35
  v_exp_f32 v35, v35
  v_mov_b32 v24, v34
  v_mul_f32 v25, s45, v34
  v_mul_f32 v16, v16, v35
  v_mul_f32 v17, v17, v35
  v_mul_f32 v18, v18, v35
  v_mul_f32 v19, v19, v35
  v_mul_f32 v20, v20, v35
  v_mul_f32 v21, v21, v35
  v_mul_f32 v22, v22, v35
  v_mul_f32 v23, v23, v35
  v_mul_f32 v26, v26, v35
A_nr7:
  v_fma_f32 v28, v28, s45, -v25
  v_fma_f32 v29, v29, s45, -v25
  v_fma_f32 v30, v30, s45, -v25
  v_fma_f32 v31, v31, s45, -v25
  v_exp_f32 v28, v28
  v_exp_f32 v29, v29
  v_exp_f32 v30, v30
  v_exp_f32 v31, v31
  s_nop 0
  v_cvt_pk_bf16_f32 v32, v28, v28
  v_cvt_pk_bf16_f32 v33, v29, v29
  v_cvt_pk_bf16_f32 v34, v30, v30
  v_cvt_pk_bf16_f32 v35, v31, v31
  v_add_f32 v28, v28, v29
  v_add_f32 v30, v30, v31
  v_add_f32 v26, v26, v28
  v_add_f32 v26, v26, v30
  v_and_b32 v36, v32, v8
  v_and_b32 v37, v32, v9
  v_and_b32 v38, v32, v10
  v_and_b32 v39, v32, v11
  s_waitcnt vmcnt(40)
  s_nop 0
  v_mfma_f32_16x16x32_bf16 v[16:19], v[176:179], v[36:39], v[16:19]
  v_mfma_f32_16x16x32_bf16 v[20:23], v[180:183], v[36:39], v[20:23]
  v_and_b32 v40, v33, v8
  v_and_b32 v41, v33, v9
  v_and_b32 v42, v33, v10
  v_and_b32 v43, v33, v11
  s_nop 0
  s_nop 0
  v_mfma_f32_16x16x32_bf16 v[16:19], v[184:187], v[40:43], v[16:19]
  v_mfma_f32_16x16x32_bf16 v[20:23], v[188:191], v[40:43], v[20:23]
  v_and_b32 v36, v34, v8
  v_and_b32 v37, v34, v9
  v_and_b32 v38, v34, v10
  v_and_b32 v39, v34, v11
  s_nop 0
  s_nop 0
  v_mfma_f32_16x16x32_bf16 v[16:19], v[192:195], v[36:39], v[16:19]
  v_mfma_f32_16x16x32_bf16 v[20:23], v[196:199], v[36:39], v[20:23]
  v_and_b32 v40, v35, v8
  v_and_b32 v41, v35, v9
  v_and_b32 v42, v35, v10
  v_and_b32 v43, v35, v11
  s_nop 0
  s_nop 0
  v_mfma_f32_16x16x32_bf16 v[16:19], v[200:203], v[40:43], v[16:19]
  v_mfma_f32_16x16x32_bf16 v[20:23], v[204:207], v[40:43], v[20:23]
  s_and_b32 s49, s48, 0xfffff
  s_or_b32 s49, s49, s70
  s_cmp_ge_u32 s48, s71
  s_cselect_b32 s49, 0x10000000, s49
  buffer_load_dwordx4 v[176:179], v5, s[20:23], s49 offen offset:0 nt
  buffer_load_dwordx4 v[180:183], v5, s[20:23], s49 offen offset:256 nt
  buffer_load_dwordx4 v[184:187], v5, s[20:23], s49 offen offset:512 nt
  buffer_load_dwordx4 v[188:191], v5, s[20:23], s49 offen offset:768 nt
  buffer_load_dwordx4 v[192:195], v5, s[20:23], s49 offen offset:1024 nt
  buffer_load_dwordx4 v[196:199], v5, s[20:23], s49 offen offset:1280 nt
  buffer_load_dwordx4 v[200:203], v5, s[20:23], s49 offen offset:1536 nt
  buffer_load_dwordx4 v[204:207], v5, s[20:23], s49 offen offset:1792 nt
  s_add_u32 s48, s48, 8192
  s_waitcnt vmcnt(40)
  v_mfma_f32_16x16x32_bf16 v[12:15], a[0:3], v[48:51], 0
  v_mfma_f32_16x16x32_bf16 v[12:15], a[4:7], v[52:55], v[12:15]
  v_mfma_f32_16x16x32_bf16 v[12:15], a[8:11], v[56:59], v[12:15]
  v_mfma_f32_16x16x32_bf16 v[12:15], a[12:15], v[60:63], v[12:15]
  v_mfma_f32_16x16x32_bf16 v[12:15], a[16:19], v[64:67], v[12:15]
  v_mfma_f32_16x16x32_bf16 v[12:15], a[20:23], v[68:71], v[12:15]
  v_mfma_f32_16x16x32_bf16 v[12:15], a[24:27], v[72:75], v[12:15]
  v_mfma_f32_16x16x32_bf16 v[12:15], a[28:31], v[76:79], v[12:15]
  s_and_b32 s49, s47, 0xfffff
  s_or_b32 s49, s49, s70
  s_cmp_ge_u32 s47, s71
  s_cselect_b32 s49, 0x10000000, s49
  buffer_load_dwordx4 a[0:3], v4, s[16:19], s49 offen offset:0 nt
  buffer_load_dwordx4 a[4:7], v4, s[16:19], s49 offen offset:64 nt
  buffer_load_dwordx4 a[8:11], v4, s[16:19], s49 offen offset:128 nt
  buffer_load_dwordx4 a[12:15], v4, s[16:19], s49 offen offset:192 nt
  buffer_load_dwordx4 a[16:19], v4, s[16:19], s49 offen offset:256 nt
  buffer_load_dwordx4 a[20:23], v4, s[16:19], s49 offen offset:320 nt
  buffer_load_dwordx4 a[24:27], v4, s[16:19], s49 offen offset:384 nt
  buffer_load_dwordx4 a[28:31], v4, s[16:19], s49 offen offset:448 nt
  s_add_u32 s47, s47, 8192
  s_nop 0
  v_cvt_pk_bf16_f32 v32, v12, v13
  v_cvt_pk_bf16_f32 v33, v14, v15
  v_lshlrev_b32 v28, 16, v32
  v_and_b32 v29, 0xffff0000, v32
  v_lshlrev_b32 v30, 16, v33
  v_and_b32 v31, 0xffff0000, v33
  v_max3_f32 v34, v28, v29, v30
  v_max_f32 v34, v34, v31
  v_cmp_gt_f32 vcc, v34, v24
  s_cmp_eq_u64 vcc, 0
  s_cbranch_scc1 A_nr8
  v_mov_b32 v35, v34
  s_nop 1
  v_permlane32_swap_b32 v34, v35
  v_max_f32 v34, v34, v35
  v_mov_b32 v35, v34
  s_nop 1
  v_permlane16_swap_b32 v34, v35
  v_max_f32 v34, v34, v35
  v_max_f32 v34, v34, v24
  v_sub_f32 v35, v24, v34
  v_mul_f32 v35, s45, v35
  v_exp_f32 v35, v35
  v_mov_b32 v24, v34
  v_mul_f32 v25, s45, v34
  v_mul_f32 v16, v16, v35
  v_mul_f32 v17, v17, v35
  v_mul_f32 v18, v18, v35
  v_mul_f32 v19, v19, v35
  v_mul_f32 v20, v20, v35
  v_mul_f32 v21, v21, v35
  v_mul_f32 v22, v22, v35
  v_mul_f32 v23, v23, v35
  v_mul_f32 v26, v26, v35
A_nr8:
  v_fma_f32 v28, v28, s45, -v25
  v_fma_f32 v29, v29, s45, -v25
  v_fma_f32 v30, v30, s45, -v25
  v_fma_f32 v31, v31, s45, -v25
  v_exp_f32 v28, v28
  v_exp_f32 v29, v29
  v_exp_f32 v30, v30
  v_exp_f32 v31, v31
  s_nop 0
  v_cvt_pk_bf16_f32 v32, v28, v28
  v_cvt_pk_bf16_f32 v33, v29, v29
  v_cvt_pk_bf16_f32 v34, v30, v30
  v_cvt_pk_bf16_f32 v35, v31, v31
  v_add_f32 v28, v28, v29
  v_add_f32 v30, v30, v31
  v_add_f32 v26, v26, v28
  v_add_f32 v26, v26, v30
  v_and_b32 v36, v32, v8
  v_and_b32 v37, v32, v9
  v_and_b32 v38, v32, v10
  v_and_b32 v39, v32, v11
  s_waitcnt vmcnt(40)
  s_nop 0
  v_mfma_f32_16x16x32_bf16 v[16:19], a[32:35], v[36:39], v[16:19]
  v_mfma_f32_16x16x32_bf16 v[20:23], a[36:39], v[36:39], v[20:23]
  v_and_b32 v40, v33, v8
  v_and_b32 v41, v33, v9
  v_and_b32 v42, v33, v10
  v_and_b32 v43, v33, v11
  s_nop 0
  s_nop 0
  v_mfma_f32_16x16x32_bf16 v[16:19], a[40:43], v[40:43], v[16:19]
  v_mfma_f32_16x16x32_bf16 v[20:23], a[44:47], v[40:43], v[20:23]
  v_and_b32 v36, v34, v8
  v_and_b32 v37, v34, v9
  v_and_b32 v38, v34, v10
  v_and_b32 v39, v34, v11
  s_nop 0
  s_nop 0
  v_mfma_f32_16x16x32_bf16 v[16:19], a[48:51], v[36:39], v[16:19]
  v_mfma_f32_16x16x32_bf16 v[20:23], a[52:55], v[36:39], v[20:23]
  v_and_b32 v40, v35, v8
  v_and_b32 v41, v35, v9
  v_and_b32 v42, v35, v10
  v_and_b32 v43, v35, v11
  s_nop 0
  s_nop 0
  v_mfma_f32_16x16x32_bf16 v[16:19], a[56:59], v[40:43], v[16:19]
  v_mfma_f32_16x16x32_bf16 v[20:23], a[60:63], v[40:43], v[20:23]
  s_and_b32 s49, s48, 0xfffff
  s_or_b32 s49, s49, s70
  s_cmp_ge_u32 s48, s71
  s_cselect_b32 s49, 0x10000000, s49
  buffer_load_dwordx4 a[32:35], v5, s[20:23], s49 offen offset:0 nt
  buffer_load_dwordx4 a[36:39], v5, s[20:23], s49 offen offset:256 nt
  buffer_load_dwordx4 a[40:43], v5, s[20:23], s49 offen offset:512 nt
  buffer_load_dwordx4 a[44:47], v5, s[20:23], s49 offen offset:768 nt
  buffer_load_dwordx4 a[48:51], v5, s[20:23], s49 offen offset:1024 nt
  buffer_load_dwordx4 a[52:55], v5, s[20:23], s49 offen offset:1280 nt
  buffer_load_dwordx4 a[56:59], v5, s[20:23], s49 offen offset:1536 nt
  buffer_load_dwordx4 a[60:63], v5, s[20:23], s49 offen offset:1792 nt
  s_add_u32 s48, s48, 8192
  s_sub_u32 s46, s46, 1
  s_cmp_lg_u32 s46, 0
  s_cbranch_scc1 A_loop
A_w1done:
  s_nop 8
  s_branch A_fin
A_helper2:
  v_lshlrev_b32 v45, 4, v1
  s_lshl_b32 s44, s39, 14
  v_add_u32 v45, s44, v45
  s_mov_b32 s46, 4
A_hloop:
  ds_read_b128 v[80:83], v45 offset:0
  ds_read_b128 v[84:87], v45 offset:1024
  ds_read_b128 v[88:91], v45 offset:2048
  ds_read_b128 v[92:95], v45 offset:3072
  ds_read_b128 v[96:99], v45 offset:4096
  ds_read_b128 v[100:103], v45 offset:5120
  ds_read_b128 v[104:107], v45 offset:6144
  ds_read_b128 v[108:111], v45 offset:7168
  ds_read_b128 v[112:115], v45 offset:8192
  ds_read_b128 v[116:119], v45 offset:9216
  ds_read_b128 v[120:123], v45 offset:10240
  ds_read_b128 v[124:127], v45 offset:11264
  ds_read_b128 v[128:131], v45 offset:12288
  ds_read_b128 v[132:135], v45 offset:13312
  ds_read_b128 v[136:139], v45 offset:14336
  ds_read_b128 v[140:143], v45 offset:15360
  v_add_u32 v45, 32768, v45
  s_waitcnt lgkmcnt(8)
  v_mfma_f32_16x16x32_bf16 v[12:15], v[80:83], v[48:51], 0
  v_mfma_f32_16x16x32_bf16 v[12:15], v[84:87], v[52:55], v[12:15]
  v_mfma_f32_16x16x32_bf16 v[12:15], v[88:91], v[56:59], v[12:15]
  v_mfma_f32_16x16x32_bf16 v[12:15], v[92:95], v[60:63], v[12:15]
  v_mfma_f32_16x16x32_bf16 v[12:15], v[96:99], v[64:67], v[12:15]
  v_mfma_f32_16x16x32_bf16 v[12:15], v[100:103], v[68:71], v[12:15]
  v_mfma_f32_16x16x32_bf16 v[12:15], v[104:107], v[72:75], v[12:15]
  v_mfma_f32_16x16x32_bf16 v[12:15], v[108:111], v[76:79], v[12:15]
  s_nop 8
  v_cvt_pk_bf16_f32 v32, v12, v13
  v_cvt_pk_bf16_f32 v33, v14, v15
  v_lshlrev_b32 v28, 16, v32
  v_and_b32 v29, 0xffff0000, v32
  v_lshlrev_b32 v30, 16, v33
  v_and_b32 v31, 0xffff0000, v33
  v_max3_f32 v34, v28, v29, v30
  v_max_f32 v34, v34, v31
  v_cmp_gt_f32 vcc, v34, v24
  s_cmp_eq_u64 vcc, 0
  s_cbranch_scc1 A_nr9
  v_mov_b32 v35, v34
  s_nop 1
  v_permlane32_swap_b32 v34, v35
  v_max_f32 v34, v34, v35
  v_mov_b32 v35, v34
  s_nop 1
  v_permlane16_swap_b32 v34, v35
  v_max_f32 v34, v34, v35
  v_max_f32 v34, v34, v24
  v_sub_f32 v35, v24, v34
  v_mul_f32 v35, s45, v35
  v_exp_f32 v35, v35
  v_mov_b32 v24, v34
  v_mul_f32 v25, s45, v34
  v_mul_f32 v16, v16, v35
  v_mul_f32 v17, v17, v35
  v_mul_f32 v18, v18, v35
  v_mul_f32 v19, v19, v35
  v_mul_f32 v20, v20, v35
  v_mul_f32 v21, v21, v35
  v_mul_f32 v22, v22, v35
  v_mul_f32 v23, v23, v35
  v_mul_f32 v26, v26, v35
A_nr9:
  v_fma_f32 v28, v28, s45, -v25
  v_fma_f32 v29, v29, s45, -v25
  v_fma_f32 v30, v30, s45, -v25
  v_fma_f32 v31, v31, s45, -v25
  v_exp_f32 v28, v28
  v_exp_f32 v29, v29
  v_exp_f32 v30, v30
  v_exp_f32 v31, v31
  s_nop 0
  v_cvt_pk_bf16_f32 v32, v28, v28
  v_cvt_pk_bf16_f32 v33, v29, v29
  v_cvt_pk_bf16_f32 v34, v30, v30
  v_cvt_pk_bf16_f32 v35, v31, v31
  v_add_f32 v28, v28, v29
  v_add_f32 v30, v30, v31
  v_add_f32 v26, v26, v28
  v_add_f32 v26, v26, v30
  v_and_b32 v36, v32, v8
  v_and_b32 v37, v32, v9
  v_and_b32 v38, v32, v10
  v_and_b32 v39, v32, v11
  s_waitcnt lgkmcnt(0)
  s_nop 0
  v_mfma_f32_16x16x32_bf16 v[16:19], v[112:115], v[36:39], v[16:19]
  v_mfma_f32_16x16x32_bf16 v[20:23], v[116:119], v[36:39], v[20:23]
  v_and_b32 v40, v33, v8
  v_and_b32 v41, v33, v9
  v_and_b32 v42, v33, v10
  v_and_b32 v43, v33, v11
  s_nop 0
  s_nop 0
  v_mfma_f32_16x16x32_bf16 v[16:19], v[120:123], v[40:43], v[16:19]
  v_mfma_f32_16x16x32_bf16 v[20:23], v[124:127], v[40:43], v[20:23]
  v_and_b32 v36, v34, v8
  v_and_b32 v37, v34, v9
  v_and_b32 v38, v34, v10
  v_and_b32 v39, v34, v11
  s_nop 0
  s_nop 0
  v_mfma_f32_16x16x32_bf16 v[16:19], v[128:131], v[36:39], v[16:19]
  v_mfma_f32_16x16x32_bf16 v[20:23], v[132:135], v[36:39], v[20:23]
  v_and_b32 v40, v35, v8
  v_and_b32 v41, v35, v9
  v_and_b32 v42, v35, v10
  v_and_b32 v43, v35, v11
  s_nop 0
  s_nop 0
  v_mfma_f32_16x16x32_bf16 v[16:19], v[136:139], v[40:43], v[16:19]
  v_mfma_f32_16x16x32_bf16 v[20:23], v[140:143], v[40:43], v[20:23]
  s_nop 4
  s_sub_u32 s46, s46, 1
  s_cmp_lg_u32 s46, 0
  s_cbranch_scc1 A_hloop
  s_nop 4
A_fin:
  s_mov_b32 s28, s32
  s_mov_b32 s29, s33
  s_mov_b32 s30, 0x400000
  s_mov_b32 s31, 0x00020000
  v_mov_b32 v35, v26
  s_nop 1
  v_permlane32_swap_b32 v26, v35
  v_add_f32 v26, v26, v35
  v_mov_b32 v35, v26
  s_nop 1
  v_permlane16_swap_b32 v26, v35
  v_add_f32 v26, v26, v35
  v_lshlrev_b32 v44, 7, v3
  v_lshl_add_u32 v44, v2, 2, v44
  s_lshl_b32 s44, s3, 10
  s_add_u32 s44, s44, 135680
  v_add_u32 v44, s44, v44
  v_cmp_gt_u32 vcc, 8, v2
  s_nop 1
  s_mov_b64 exec, vcc
  ds_write_b32 v44, v16 offset:0
  ds_write_b32 v44, v17 offset:32
  ds_write_b32 v44, v18 offset:64
  ds_write_b32 v44, v19 offset:96
  ds_write_b32 v44, v20 offset:512
  ds_write_b32 v44, v21 offset:544
  ds_write_b32 v44, v22 offset:576
  ds_write_b32 v44, v23 offset:608
  s_mov_b64 exec, 1
  s_lshl_b32 s44, s3, 3
  s_add_u32 s44, s44, 139776
  v_mov_b32 v45, s44
  v_mov_b32 v25, v26
  ds_write_b64 v45, v[24:25]
  s_mov_b64 exec, -1
  s_lshl_b32 s73, s36, 2
  s_add_u32 s73, s73, s35
  s_sub_u32 s74, s73, 7
  s_lshl_b32 s74, s74, 4
  s_add_u32 s74, s74, s34
  s_mov_b32 s75, 0
  s_cmp_lt_u32 s73, 7
  s_cselect_b32 s75, 1, 0
  s_cmp_lt_u32 s74, 56
  s_cselect_b32 s75, 2, s75
  s_load_dwordx2 s[54:55], s[0:1], 72
  s_mov_b32 s46, 0x05040100
  s_mov_b32 s47, 0x07060302
  s_load_dwordx2 s[64:65], s[0:1], 32
  s_load_dwordx4 s[76:79], s[0:1], 48
  s_cmp_lg_u32 s3, 3
  s_cbranch_scc1 A_bar2
  s_sub_u32 s43, s73, 12
  s_lshl_b32 s43, s43, 4
  s_add_u32 s43, s43, s34
  s_cmp_ge_u32 s43, 56
  s_cbranch_scc1 A_bar2
  s_sleep 127
  s_sleep 127
  v_lshlrev_b32 v7, 4, v1
  v_mov_b32 v32, 0
  v_mov_b32 v33, 0
  v_mov_b32 v34, 0
  v_mov_b32 v35, 0
  s_lshl_b32 s44, s43, 10
  s_add_u32 s44, s44, 65536
  buffer_store_dwordx4 v[32:35], v7, s[28:31], s44 offen sc1
  s_lshl_b32 s44, s43, 7
  s_add_u32 s44, s44, 163840
  v_mov_b32 v28, s72
  s_waitcnt vmcnt(0)
  s_mov_b64 exec, 1
  buffer_store_dword v28, v32, s[28:31], s44 offen sc1
  s_mov_b64 exec, -1
A_bar2:
  s_waitcnt vmcnt(0) lgkmcnt(0)
  s_barrier
  v_mov_b32 v45, 139776
  ds_read_b128 v[48:51], v45
  ds_read_b128 v[52:55], v45 offset:16
  v_lshlrev_b32 v46, 2, v0
  v_add_u32 v47, 135680, v46
  ds_read_b32 v56, v47 offset:0
  ds_read_b32 v57, v47 offset:1024
  ds_read_b32 v58, v47 offset:2048
  ds_read_b32 v59, v47 offset:3072
  v_lshlrev_b32 v47, 3, v0
  v_mov_b32 v45, 0
  s_mov_b32 s60, s54
  s_mov_b32 s61, s55
  s_mov_b32 s62, 256
  s_mov_b32 s63, 0x00020000
  s_waitcnt lgkmcnt(0)
  v_max3_f32 v60, v48, v50, v52
  v_max_f32 v60, v60, v54
  v_sub_f32 v64, v48, v60
  v_mul_f32 v64, s45, v64
  v_exp_f32 v64, v64
  v_sub_f32 v65, v50, v60
  v_mul_f32 v65, s45, v65
  v_exp_f32 v65, v65
  v_sub_f32 v66, v52, v60
  v_mul_f32 v66, s45, v66
  v_exp_f32 v66, v66
  v_sub_f32 v67, v54, v60
  v_mul_f32 v67, s45, v67
  v_exp_f32 v67, v67
  v_mov_b32 v69, s72
  v_mul_f32 v68, v64, v56
  v_mul_f32 v62, v64, v49
  v_fma_f32 v68, v65, v57, v68
  v_fma_f32 v62, v65, v51, v62
  v_fma_f32 v68, v66, v58, v68
  v_fma_f32 v62, v66, v53, v62
  v_fma_f32 v68, v67, v59, v68
  v_fma_f32 v62, v67, v55, v62
  s_lshl_b32 s44, s37, 11
  s_add_u32 s44, s44, 2097152
  buffer_store_dwordx2 v[68:69], v47, s[28:31], s44 offen sc1
  v_mov_b32 v61, s72
  v_mov_b32 v63, s72
  s_lshl_b32 s44, s34, 8
  s_add_u32 s56, s44, 131072
  s_lshl_b32 s44, s73, 4
  s_add_u32 s44, s44, s56
  v_cmp_eq_u32 vcc, 0, v0
  s_and_saveexec_b64 s[52:53], vcc
  s_cbranch_execz A_noml
  buffer_store_dwordx4 v[60:63], v45, s[28:31], s44 offen sc1
A_noml:
  s_mov_b64 exec, s[52:53]
  s_cmp_eq_u32 s75, 0
  s_cbranch_scc1 A_end
  s_cmp_eq_u32 s75, 2
  s_cbranch_scc1 C_stage
  s_mov_b32 s12, s64
  s_mov_b32 s13, s65
  s_mov_b32 s14, 3670016
  s_mov_b32 s15, 0x00020000
  v_lshrrev_b32 v4, 3, v2
  v_lshl_add_u32 v4, v4, 2, v3
  v_mul_u32_u24 v5, 7168, v4
  v_and_b32 v6, 7, v2
  v_lshl_add_u32 v5, v6, 4, v5
  v_add_u32 v6, 3584, v5
  s_lshl_b32 s57, s34, 8
  s_lshl_b32 s58, s3, 6
  s_add_u32 s57, s57, s58
  s_mul_i32 s57, s57, 896
  s_lshl_b32 s58, s73, 7
  s_add_u32 s57, s57, s58
  buffer_load_dwordx4 v[192:195], v5, s[12:15], s57 offen offset:0
  buffer_load_dwordx4 v[196:199], v5, s[12:15], s57 offen offset:896
  buffer_load_dwordx4 v[200:203], v5, s[12:15], s57 offen offset:1792
  buffer_load_dwordx4 v[204:207], v5, s[12:15], s57 offen offset:2688
  buffer_load_dwordx4 v[208:211], v6, s[12:15], s57 offen offset:0
  buffer_load_dwordx4 v[212:215], v6, s[12:15], s57 offen offset:896
  buffer_load_dwordx4 v[216:219], v6, s[12:15], s57 offen offset:1792
  buffer_load_dwordx4 v[220:223], v6, s[12:15], s57 offen offset:2688
  v_min_u32 v53, 55, v1
  v_lshlrev_b32 v53, 7, v53
  s_mov_b32 s43, 163840
  buffer_load_dword v52, v53, s[28:31], s43 offen sc1
  s_waitcnt vmcnt(1)
  v_perm_b32 v96, v196, v192, s46
  v_perm_b32 v100, v196, v192, s47
  v_perm_b32 v97, v204, v200, s46
  v_perm_b32 v101, v204, v200, s47
  v_perm_b32 v98, v212, v208, s46
  v_perm_b32 v102, v212, v208, s47
  v_perm_b32 v99, v220, v216, s46
  v_perm_b32 v103, v220, v216, s47
  v_perm_b32 v104, v197, v193, s46
  v_perm_b32 v108, v197, v193, s47
  v_perm_b32 v105, v205, v201, s46
  v_perm_b32 v109, v205, v201, s47
  v_perm_b32 v106, v213, v209, s46
  v_perm_b32 v110, v213, v209, s47
  v_perm_b32 v107, v221, v217, s46
  v_perm_b32 v111, v221, v217, s47
  v_perm_b32 v112, v198, v194, s46
  v_perm_b32 v116, v198, v194, s47
  v_perm_b32 v113, v206, v202, s46
  v_perm_b32 v117, v206, v202, s47
  v_perm_b32 v114, v214, v210, s46
  v_perm_b32 v118, v214, v210, s47
  v_perm_b32 v115, v222, v218, s46
  v_perm_b32 v119, v222, v218, s47
  v_perm_b32 v120, v199, v195, s46
  v_perm_b32 v124, v199, v195, s47
  v_perm_b32 v121, v207, v203, s46
  v_perm_b32 v125, v207, v203, s47
  v_perm_b32 v122, v215, v211, s46
  v_perm_b32 v126, v215, v211, s47
  v_perm_b32 v123, v223, v219, s46
  v_perm_b32 v127, v223, v219, s47
  v_lshlrev_b32 v8, 4, v2
  s_lshl_b32 s57, s34, 13
  s_add_u32 s57, s57, 2097152
  s_mov_b32 s59, 400000
B_pollZ:
  s_waitcnt vmcnt(0)
  v_cmp_eq_u32 vcc, s72, v52
  s_cmp_eq_u64 vcc, -1
  s_cbranch_scc1 B_pollA
  s_sub_u32 s59, s59, 1
  s_cmp_lt_i32 s59, 1
  s_cbranch_scc1 B_pollA
  s_sleep 20
  buffer_load_dword v52, v53, s[28:31], s43 offen sc1
  s_branch B_pollZ
B_pollA:
  buffer_load_dwordx4 v[48:51], v8, s[28:31], s56 offen sc1
  s_waitcnt vmcnt(0)
  v_cmp_eq_u32 vcc, s72, v49
  v_cmp_eq_u32 s[50:51], s72, v51
  s_and_b32 s58, vcc_lo, s50
  s_and_b32 s58, s58, 0xffff
  s_bcnt1_i32_b32 s58, s58
  s_cmp_ge_u32 s58, 15
  s_cbranch_scc1 B_pollB
  s_sub_u32 s59, s59, 1
  s_cmp_lt_i32 s59, 1
  s_cbranch_scc1 B_pollB
  s_sleep 4
  s_branch B_pollA
B_pollB:
  buffer_load_dwordx4 v[48:51], v8, s[28:31], s56 offen sc1
  s_mov_b32 s58, s57
  buffer_load_dwordx2 v[160:161], v47, s[28:31], s58 offen offset:0 sc1
  buffer_load_dwordx2 v[162:163], v47, s[28:31], s58 offen offset:2048 sc1
  s_add_u32 s43, s58, 4096
  buffer_load_dwordx2 v[164:165], v47, s[28:31], s43 offen offset:0 sc1
  buffer_load_dwordx2 v[166:167], v47, s[28:31], s43 offen offset:2048 sc1
  s_add_u32 s58, s58, 131072
  buffer_load_dwordx2 v[168:169], v47, s[28:31], s58 offen offset:0 sc1
  buffer_load_dwordx2 v[170:171], v47, s[28:31], s58 offen offset:2048 sc1
  s_add_u32 s43, s58, 4096
  buffer_load_dwordx2 v[172:173], v47, s[28:31], s43 offen offset:0 sc1
  buffer_load_dwordx2 v[174:175], v47, s[28:31], s43 offen offset:2048 sc1
  s_add_u32 s58, s58, 131072
  buffer_load_dwordx2 v[176:177], v47, s[28:31], s58 offen offset:0 sc1
  buffer_load_dwordx2 v[178:179], v47, s[28:31], s58 offen offset:2048 sc1
  s_add_u32 s43, s58, 4096
  buffer_load_dwordx2 v[180:181], v47, s[28:31], s43 offen offset:0 sc1
  buffer_load_dwordx2 v[182:183], v47, s[28:31], s43 offen offset:2048 sc1
  s_add_u32 s58, s58, 131072
  buffer_load_dwordx2 v[184:185], v47, s[28:31], s58 offen offset:0 sc1
  buffer_load_dwordx2 v[186:187], v47, s[28:31], s58 offen offset:2048 sc1
  s_add_u32 s43, s58, 4096
  buffer_load_dwordx2 v[188:189], v47, s[28:31], s43 offen offset:0 sc1
  buffer_load_dwordx2 v[190:191], v47, s[28:31], s43 offen offset:2048 sc1
  s_add_u32 s58, s58, 131072
  s_waitcnt vmcnt(0)
  v_xor_b32 v53, s72, v49
  v_xor_b32 v54, s72, v51
  v_or_b32 v53, v53, v54
  v_xor_b32 v54, s72, v161
  v_or_b32 v53, v53, v54
  v_xor_b32 v54, s72, v163
  v_or_b32 v53, v53, v54
  v_xor_b32 v54, s72, v165
  v_or_b32 v53, v53, v54
  v_xor_b32 v54, s72, v167
  v_or_b32 v53, v53, v54
  v_xor_b32 v54, s72, v169
  v_or_b32 v53, v53, v54
  v_xor_b32 v54, s72, v171
  v_or_b32 v53, v53, v54
  v_xor_b32 v54, s72, v173
  v_or_b32 v53, v53, v54
  v_xor_b32 v54, s72, v175
  v_or_b32 v53, v53, v54
  v_xor_b32 v54, s72, v177
  v_or_b32 v53, v53, v54
  v_xor_b32 v54, s72, v179
  v_or_b32 v53, v53, v54
  v_xor_b32 v54, s72, v181
  v_or_b32 v53, v53, v54
  v_xor_b32 v54, s72, v183
  v_or_b32 v53, v53, v54
  v_xor_b32 v54, s72, v185
  v_or_b32 v53, v53, v54
  v_xor_b32 v54, s72, v187
  v_or_b32 v53, v53, v54
  v_xor_b32 v54, s72, v189
  v_or_b32 v53, v53, v54
  v_xor_b32 v54, s72, v191
  v_or_b32 v53, v53, v54
  v_cmp_eq_u32 vcc, 0, v53
  s_cmp_eq_u64 vcc, -1
  s_cbranch_scc1 B_go
  s_sub_u32 s59, s59, 1
  s_cmp_lt_i32 s59, 1
  s_cbranch_scc1 B_go
  s_sleep 4
  s_branch B_pollB
B_go:
  v_mov_b32 v53, v48
  s_nop 1
  v_max_f32_dpp v53, v53, v53 quad_perm:[1,0,3,2] row_mask:0xf bank_mask:0xf
  s_nop 1
  v_max_f32_dpp v53, v53, v53 quad_perm:[2,3,0,1] row_mask:0xf bank_mask:0xf
  v_sub_f32 v53, v48, v53
  v_mul_f32 v53, s45, v53
  v_exp_f32 v53, v53
  s_nop 0
  v_mul_f32 v54, v53, v50
  s_nop 1
  v_add_f32_dpp v54, v54, v54 quad_perm:[1,0,3,2] row_mask:0xf bank_mask:0xf
  s_nop 1
  v_add_f32_dpp v54, v54, v54 quad_perm:[2,3,0,1] row_mask:0xf bank_mask:0xf
  v_rcp_f32 v55, v54
  s_nop 0
  v_fma_f32 v56, -v55, v54, 1.0
  v_fma_f32 v55, v56, v55, v55
  v_mul_f32 v53, v53, v55
  s_nop 0
  v_readlane_b32 s4, v53, 0
  v_readlane_b32 s5, v53, 1
  v_readlane_b32 s6, v53, 2
  v_readlane_b32 s7, v53, 3
  v_readlane_b32 s8, v53, 4
  v_readlane_b32 s9, v53, 5
  v_readlane_b32 s10, v53, 6
  v_readlane_b32 s11, v53, 7
  v_readlane_b32 s76, v53, 8
  v_readlane_b32 s77, v53, 9
  v_readlane_b32 s78, v53, 10
  v_readlane_b32 s79, v53, 11
  v_readlane_b32 s64, v53, 12
  v_readlane_b32 s65, v53, 13
  v_readlane_b32 s66, v53, 14
  v_readlane_b32 s67, v53, 15
  v_lshlrev_b32 v10, 1, v1
  s_lshl_b32 s58, s3, 12
  s_add_u32 s58, s58, 65536
  v_add_u32 v10, s58, v10
  v_mul_f32 v56, s4, v160
  v_fma_f32 v56, s5, v162, v56
  v_fma_f32 v56, s6, v164, v56
  v_fma_f32 v56, s7, v166, v56
  v_cvt_pk_bf16_f32 v56, v56, v56
  ds_write_b16 v10, v56 offset:0
  v_mul_f32 v57, s8, v168
  v_fma_f32 v57, s9, v170, v57
  v_fma_f32 v57, s10, v172, v57
  v_fma_f32 v57, s11, v174, v57
  v_cvt_pk_bf16_f32 v57, v57, v57
  ds_write_b16 v10, v57 offset:128
  v_mul_f32 v58, s76, v176
  v_fma_f32 v58, s77, v178, v58
  v_fma_f32 v58, s78, v180, v58
  v_fma_f32 v58, s79, v182, v58
  v_cvt_pk_bf16_f32 v58, v58, v58
  ds_write_b16 v10, v58 offset:256
  v_mul_f32 v59, s64, v184
  v_fma_f32 v59, s65, v186, v59
  v_fma_f32 v59, s66, v188, v59
  v_fma_f32 v59, s67, v190, v59
  v_cvt_pk_bf16_f32 v59, v59, v59
  ds_write_b16 v10, v59 offset:384
  v_and_b32 v11, 3, v2
  v_lshlrev_b32 v11, 7, v11
  v_bfe_u32 v12, v2, 2, 1
  v_lshl_add_u32 v12, v12, 2, v3
  v_lshl_add_u32 v11, v12, 4, v11
  v_add_u32 v11, s58, v11
  s_waitcnt lgkmcnt(0)
  ds_read_b128 v[12:15], v11
  v_lshrrev_b32 v16, 3, v2
  v_cmp_eq_u32 s[50:51], v16, v3
  v_and_b32 v17, 7, v2
  v_lshlrev_b32 v17, 7, v17
  v_lshl_add_u32 v17, v16, 10, v17
  v_add_u32 v17, s58, v17
  v_lshlrev_b32 v18, 4, v1
  v_add_u32 v18, s58, v18
  s_waitcnt lgkmcnt(0)
  s_nop 1
  v_mfma_f32_16x16x32_bf16 v[128:131], v[12:15], v[96:99], 0
  v_mfma_f32_16x16x32_bf16 v[132:135], v[12:15], v[100:103], 0
  v_mfma_f32_16x16x32_bf16 v[136:139], v[12:15], v[104:107], 0
  v_mfma_f32_16x16x32_bf16 v[140:143], v[12:15], v[108:111], 0
  v_mfma_f32_16x16x32_bf16 v[144:147], v[12:15], v[112:115], 0
  v_mfma_f32_16x16x32_bf16 v[148:151], v[12:15], v[116:119], 0
  v_mfma_f32_16x16x32_bf16 v[152:155], v[12:15], v[120:123], 0
  v_mfma_f32_16x16x32_bf16 v[156:159], v[12:15], v[124:127], 0
  s_mul_i32 s43, s3, 7168
  s_lshl_b32 s44, s73, 8
  s_add_u32 s43, s43, s44
  s_add_u32 s43, s43, 65536
  v_lshlrev_b32 v19, 2, v1
  s_nop 3
  s_mov_b64 exec, s[50:51]
  ds_write_b128 v17, v[128:131] offset:1024
  ds_write_b128 v17, v[132:135] offset:1040
  ds_write_b128 v17, v[136:139] offset:1056
  ds_write_b128 v17, v[140:143] offset:1072
  ds_write_b128 v17, v[144:147] offset:1088
  ds_write_b128 v17, v[148:151] offset:1104
  ds_write_b128 v17, v[152:155] offset:1120
  ds_write_b128 v17, v[156:159] offset:1136
  s_mov_b64 exec, -1
  s_waitcnt lgkmcnt(0)
  ds_read_b128 v[20:23], v18 offset:1024
  ds_read_b128 v[24:27], v18 offset:2048
  s_waitcnt lgkmcnt(0)
  v_add_f32 v20, v20, v24
  buffer_atomic_add_f32 v20, v19, s[28:31], s43 offen offset:0
  v_add_f32 v21, v21, v25
  buffer_atomic_add_f32 v21, v19, s[28:31], s43 offen offset:1792
  v_add_f32 v22, v22, v26
  s_add_u32 s43, s43, 3584
  buffer_atomic_add_f32 v22, v19, s[28:31], s43 offen offset:0
  v_add_f32 v23, v23, v27
  buffer_atomic_add_f32 v23, v19, s[28:31], s43 offen offset:1792
  s_waitcnt vmcnt(0)
  v_mov_b32 v20, 139844
  v_mov_b32 v21, 1
  s_mov_b64 exec, 1
  ds_add_rtn_u32 v22, v20, v21
  s_waitcnt lgkmcnt(0)
  v_readfirstlane_b32 s58, v22
  s_cmp_lg_u32 s58, 3
  s_cbranch_scc1 B_nod
  s_lshl_b32 s43, s73, 4
  s_add_u32 s43, s43, s34
  s_lshl_b32 s43, s43, 7
  s_add_u32 s43, s43, 139264
  v_mov_b32 v20, s72
  v_mov_b32 v21, s72
  buffer_store_dwordx2 v[20:21], v45, s[28:31], s43 offen sc1
B_nod:
  s_mov_b64 exec, -1
  s_branch A_end
C_stage:
  s_load_dwordx2 s[4:5], s[0:1], 0
  s_load_dwordx8 s[8:15], s[0:1], 48
  s_mov_b32 s33, s74
  v_cmp_gt_u32 s[40:41], 56, v1
  v_lshlrev_b32 v7, 4, v1
  v_mov_b32 v44, 0x1000000
  v_cndmask_b32 v7, v44, v7, s[40:41]
  v_lshlrev_b32 v8, 1, v7
  s_mul_i32 s38, s3, 896
  s_mul_i32 s39, s3, 1792
  s_add_u32 s42, s39, 65536
  v_mov_b32 v45, 0
  s_waitcnt lgkmcnt(0)
  s_mov_b32 s16, s4
  s_mov_b32 s17, s5
  s_mov_b32 s18, 3584
  s_mov_b32 s19, 0x00020000
  s_mov_b32 s52, s12
  s_mov_b32 s53, s13
  s_mov_b32 s54, 3584
  s_mov_b32 s55, 0x00020000
  s_mov_b32 s56, s14
  s_mov_b32 s57, s15
  s_mov_b32 s58, 256
  s_mov_b32 s59, 0x00020000
  buffer_load_dwordx4 v[20:23], v7, s[16:19], s38 offen
  s_mov_b32 s20, s8
  s_mov_b32 s21, s9
  s_mov_b32 s22, 1605632
  s_mov_b32 s23, 0x00020000
  s_mov_b32 s24, s10
  s_mov_b32 s25, s11
  s_mov_b32 s26, 1605632
  s_mov_b32 s27, 0x00020000
  v_lshrrev_b32 v4, 2, v2
  v_lshl_add_u32 v4, v4, 2, v3
  v_mul_u32_u24 v4, 28672, v4
  v_and_b32 v5, 3, v2
  v_lshl_add_u32 v4, v5, 4, v4
  v_mul_u32_u24 v5, 7168, v3
  v_lshl_add_u32 v5, v2, 4, v5
  v_add_u32 v6, 3584, v5
  s_mul_i32 s36, s3, 458752
  s_lshl_b32 s37, s33, 6
  s_add_u32 s36, s36, s37
  s_mul_i32 s37, s33, 28672
  s_lshl_b32 s38, s3, 8
  s_add_u32 s37, s37, s38
  buffer_load_dwordx4 v[64:67], v4, s[20:23], s36 offen offset:0
  buffer_load_dwordx4 v[68:71], v4, s[20:23], s36 offen offset:3584
  s_add_u32 s36, s36, 7168
  buffer_load_dwordx4 v[72:75], v4, s[20:23], s36 offen offset:0
  buffer_load_dwordx4 v[76:79], v4, s[20:23], s36 offen offset:3584
  s_add_u32 s36, s36, 7168
  buffer_load_dwordx4 v[80:83], v4, s[20:23], s36 offen offset:0
  buffer_load_dwordx4 v[84:87], v4, s[20:23], s36 offen offset:3584
  s_add_u32 s36, s36, 7168
  buffer_load_dwordx4 v[88:91], v4, s[20:23], s36 offen offset:0
  buffer_load_dwordx4 v[92:95], v4, s[20:23], s36 offen offset:3584
  s_add_u32 s36, s36, 7168
  buffer_load_dwordx4 v[96:99], v5, s[24:27], s37 offen offset:0
  buffer_load_dwordx4 v[100:103], v5, s[24:27], s37 offen offset:896
  buffer_load_dwordx4 v[104:107], v5, s[24:27], s37 offen offset:1792
  buffer_load_dwordx4 v[108:111], v5, s[24:27], s37 offen offset:2688
  buffer_load_dwordx4 v[112:115], v6, s[24:27], s37 offen offset:0
  buffer_load_dwordx4 v[116:119], v6, s[24:27], s37 offen offset:896
  buffer_load_dwordx4 v[120:123], v6, s[24:27], s37 offen offset:1792
  buffer_load_dwordx4 v[124:127], v6, s[24:27], s37 offen offset:2688
  v_lshlrev_b32 v9, 4, v1
  s_lshl_b32 s38, s3, 10
  v_add_u32 v9, s38, v9
  v_add_u32 v9, 65536, v9
  v_and_b32 v10, 3, v2
  v_lshlrev_b32 v10, 10, v10
  v_lshrrev_b32 v11, 2, v2
  v_lshl_add_u32 v11, v11, 2, v3
  v_lshl_add_u32 v10, v11, 4, v10
  s_lshl_b32 s38, s3, 8
  v_add_u32 v10, s38, v10
  v_add_u32 v10, 65536, v10
  v_lshrrev_b32 v192, 2, v2
  v_cmp_eq_u32 s[50:51], v192, v3
  v_and_b32 v193, 3, v2
  v_lshlrev_b32 v193, 7, v193
  v_lshl_add_u32 v193, v192, 9, v193
  s_lshl_b32 s38, s3, 11
  v_add_u32 v193, s38, v193
  v_add_u32 v193, 65536, v193
  v_lshlrev_b32 v194, 3, v1
  v_add_u32 v194, 65536, v194
  v_and_b32 v195, 1, v1
  v_lshlrev_b32 v195, 7, v195
  v_lshrrev_b32 v196, 1, v1
  v_lshl_add_u32 v195, v196, 1, v195
  s_lshl_b32 s38, s3, 8
  v_add_u32 v195, s38, v195
  v_add_u32 v195, 65536, v195
  v_and_b32 v196, 3, v2
  v_lshlrev_b32 v196, 6, v196
  v_lshl_add_u32 v196, v3, 4, v196
  v_add_u32 v196, s38, v196
  v_add_u32 v196, 65536, v196
  v_lshlrev_b32 v197, 7, v2
  s_lshl_b32 s38, s3, 11
  v_add_u32 v197, s38, v197
  v_add_u32 v197, 65536, v197
  v_lshlrev_b32 v198, 4, v1
  v_add_u32 v198, s38, v198
  v_add_u32 v198, 65536, v198
  v_lshlrev_b32 v199, 2, v1
  s_and_b32 s44, s33, 3
  s_mul_i32 s44, s44, 7168
  s_lshl_b32 s38, s3, 9
  s_add_u32 s44, s44, s38
  s_add_u32 s44, s44, 94208
  s_mov_b32 s43, 139264
  v_lshlrev_b32 v200, 3, v8
  s_waitcnt vmcnt(16)
  v_lshlrev_b32 v24, 16, v20
  v_and_b32 v25, 0xffff0000, v20
  v_lshlrev_b32 v26, 16, v21
  v_and_b32 v27, 0xffff0000, v21
  v_lshlrev_b32 v28, 16, v22
  v_and_b32 v29, 0xffff0000, v22
  v_lshlrev_b32 v30, 16, v23
  v_and_b32 v31, 0xffff0000, v23
  s_waitcnt vmcnt(8)
  v_perm_b32 v128, v68, v64, s46
  v_perm_b32 v132, v68, v64, s47
  v_perm_b32 v129, v76, v72, s46
  v_perm_b32 v133, v76, v72, s47
  v_perm_b32 v130, v84, v80, s46
  v_perm_b32 v134, v84, v80, s47
  v_perm_b32 v131, v92, v88, s46
  v_perm_b32 v135, v92, v88, s47
  v_perm_b32 v136, v69, v65, s46
  v_perm_b32 v140, v69, v65, s47
  v_perm_b32 v137, v77, v73, s46
  v_perm_b32 v141, v77, v73, s47
  v_perm_b32 v138, v85, v81, s46
  v_perm_b32 v142, v85, v81, s47
  v_perm_b32 v139, v93, v89, s46
  v_perm_b32 v143, v93, v89, s47
  v_perm_b32 v144, v70, v66, s46
  v_perm_b32 v148, v70, v66, s47
  v_perm_b32 v145, v78, v74, s46
  v_perm_b32 v149, v78, v74, s47
  v_perm_b32 v146, v86, v82, s46
  v_perm_b32 v150, v86, v82, s47
  v_perm_b32 v147, v94, v90, s46
  v_perm_b32 v151, v94, v90, s47
  v_perm_b32 v152, v71, v67, s46
  v_perm_b32 v156, v71, v67, s47
  v_perm_b32 v153, v79, v75, s46
  v_perm_b32 v157, v79, v75, s47
  v_perm_b32 v154, v87, v83, s46
  v_perm_b32 v158, v87, v83, s47
  v_perm_b32 v155, v95, v91, s46
  v_perm_b32 v159, v95, v91, s47
  s_waitcnt vmcnt(0)
  v_perm_b32 v160, v100, v96, s46
  v_perm_b32 v164, v100, v96, s47
  v_perm_b32 v161, v108, v104, s46
  v_perm_b32 v165, v108, v104, s47
  v_perm_b32 v162, v116, v112, s46
  v_perm_b32 v166, v116, v112, s47
  v_perm_b32 v163, v124, v120, s46
  v_perm_b32 v167, v124, v120, s47
  v_perm_b32 v168, v101, v97, s46
  v_perm_b32 v172, v101, v97, s47
  v_perm_b32 v169, v109, v105, s46
  v_perm_b32 v173, v109, v105, s47
  v_perm_b32 v170, v117, v113, s46
  v_perm_b32 v174, v117, v113, s47
  v_perm_b32 v171, v125, v121, s46
  v_perm_b32 v175, v125, v121, s47
  v_perm_b32 v176, v102, v98, s46
  v_perm_b32 v180, v102, v98, s47
  v_perm_b32 v177, v110, v106, s46
  v_perm_b32 v181, v110, v106, s47
  v_perm_b32 v178, v118, v114, s46
  v_perm_b32 v182, v118, v114, s47
  v_perm_b32 v179, v126, v122, s46
  v_perm_b32 v183, v126, v122, s47
  v_perm_b32 v184, v103, v99, s46
  v_perm_b32 v188, v103, v99, s47
  v_perm_b32 v185, v111, v107, s46
  v_perm_b32 v189, v111, v107, s47
  v_perm_b32 v186, v119, v115, s46
  v_perm_b32 v190, v119, v115, s47
  v_perm_b32 v187, v127, v123, s46
  v_perm_b32 v191, v127, v123, s47
  s_mov_b32 s59, 1000000
  s_cmp_lg_u32 s3, 0
  s_cbranch_scc1 C_go
C_poll:
  buffer_load_dword v46, v200, s[28:31], s43 offen sc1
  buffer_load_dword v47, v200, s[28:31], s43 offen offset:128 sc1
  s_waitcnt vmcnt(0)
  v_cmp_eq_u32 vcc, s72, v46
  v_cmp_eq_u32 s[48:49], s72, v47
  s_and_b64 vcc, vcc, s[48:49]
  s_cmp_eq_u64 vcc, s[40:41]
  s_cbranch_scc1 C_go
  s_sub_u32 s59, s59, 1
  s_cmp_lt_i32 s59, 1
  s_cbranch_scc1 C_go
  s_sleep 4
  s_branch C_poll
C_go:
  s_barrier
  s_mov_b32 s56, s14
  s_mov_b32 s57, s15
  s_mov_b32 s58, 256
  s_mov_b32 s59, 0x00020000
  buffer_load_dwordx4 v[12:15], v8, s[28:31], s42 offen sc1
  buffer_load_dwordx4 v[16:19], v8, s[28:31], s42 offen offset:16 sc1
  s_add_u32 s42, s42, 7168
  buffer_load_dwordx4 v[64:67], v8, s[28:31], s42 offen sc1
  buffer_load_dwordx4 v[68:71], v8, s[28:31], s42 offen offset:16 sc1
  s_add_u32 s42, s42, 7168
  buffer_load_dwordx4 v[72:75], v8, s[28:31], s42 offen sc1
  buffer_load_dwordx4 v[76:79], v8, s[28:31], s42 offen offset:16 sc1
  s_add_u32 s42, s42, 7168
  buffer_load_dwordx4 v[80:83], v8, s[28:31], s42 offen sc1
  buffer_load_dwordx4 v[84:87], v8, s[28:31], s42 offen offset:16 sc1
  s_add_u32 s42, s42, 7168
  s_waitcnt vmcnt(0)
  v_add_f32 v12, v12, v64
  v_add_f32 v72, v72, v80
  v_add_f32 v12, v12, v72
  v_add_f32 v13, v13, v65
  v_add_f32 v73, v73, v81
  v_add_f32 v13, v13, v73
  v_add_f32 v14, v14, v66
  v_add_f32 v74, v74, v82
  v_add_f32 v14, v14, v74
  v_add_f32 v15, v15, v67
  v_add_f32 v75, v75, v83
  v_add_f32 v15, v15, v75
  v_add_f32 v16, v16, v68
  v_add_f32 v76, v76, v84
  v_add_f32 v16, v16, v76
  v_add_f32 v17, v17, v69
  v_add_f32 v77, v77, v85
  v_add_f32 v17, v17, v77
  v_add_f32 v18, v18, v70
  v_add_f32 v78, v78, v86
  v_add_f32 v18, v18, v78
  v_add_f32 v19, v19, v71
  v_add_f32 v79, v79, v87
  v_add_f32 v19, v19, v79
  v_cvt_pk_bf16_f32 v32, v12, v13
  v_lshlrev_b32 v33, 16, v32
  v_and_b32 v34, 0xffff0000, v32
  v_add_f32 v33, v33, v24
  v_add_f32 v34, v34, v25
  v_cvt_pk_bf16_f32 v32, v33, v34
  v_lshlrev_b32 v24, 16, v32
  v_and_b32 v25, 0xffff0000, v32
  v_cvt_pk_bf16_f32 v32, v14, v15
  v_lshlrev_b32 v33, 16, v32
  v_and_b32 v34, 0xffff0000, v32
  v_add_f32 v33, v33, v26
  v_add_f32 v34, v34, v27
  v_cvt_pk_bf16_f32 v32, v33, v34
  v_lshlrev_b32 v26, 16, v32
  v_and_b32 v27, 0xffff0000, v32
  v_cvt_pk_bf16_f32 v32, v16, v17
  v_lshlrev_b32 v33, 16, v32
  v_and_b32 v34, 0xffff0000, v32
  v_add_f32 v33, v33, v28
  v_add_f32 v34, v34, v29
  v_cvt_pk_bf16_f32 v32, v33, v34
  v_lshlrev_b32 v28, 16, v32
  v_and_b32 v29, 0xffff0000, v32
  v_cvt_pk_bf16_f32 v32, v18, v19
  v_lshlrev_b32 v33, 16, v32
  v_and_b32 v34, 0xffff0000, v32
  v_add_f32 v33, v33, v30
  v_add_f32 v34, v34, v31
  v_cvt_pk_bf16_f32 v32, v33, v34
  v_lshlrev_b32 v30, 16, v32
  v_and_b32 v31, 0xffff0000, v32
  s_nop 0
  v_readfirstlane_b32 s60, v24
  s_nop 1
  v_subrev_f32 v12, s60, v24
  v_subrev_f32 v13, s60, v25
  v_subrev_f32 v14, s60, v26
  v_subrev_f32 v15, s60, v27
  v_subrev_f32 v16, s60, v28
  v_subrev_f32 v17, s60, v29
  v_subrev_f32 v18, s60, v30
  v_subrev_f32 v19, s60, v31
  v_add_f32 v32, v12, v13
  v_mul_f32 v33, v12, v12
  v_fma_f32 v33, v13, v13, v33
  v_add_f32 v32, v32, v14
  v_fma_f32 v33, v14, v14, v33
  v_add_f32 v32, v32, v15
  v_fma_f32 v33, v15, v15, v33
  v_add_f32 v32, v32, v16
  v_fma_f32 v33, v16, v16, v33
  v_add_f32 v32, v32, v17
  v_fma_f32 v33, v17, v17, v33
  v_add_f32 v32, v32, v18
  v_fma_f32 v33, v18, v18, v33
  v_add_f32 v32, v32, v19
  v_fma_f32 v33, v19, v19, v33
  v_cndmask_b32 v32, 0, v32, s[40:41]
  v_cndmask_b32 v33, 0, v33, s[40:41]
  s_nop 0
  v_add_f32_dpp v32, v32, v32 quad_perm:[1,0,3,2] row_mask:0xf bank_mask:0xf
  v_add_f32_dpp v33, v33, v33 quad_perm:[1,0,3,2] row_mask:0xf bank_mask:0xf
  s_nop 0
  v_add_f32_dpp v32, v32, v32 quad_perm:[2,3,0,1] row_mask:0xf bank_mask:0xf
  v_add_f32_dpp v33, v33, v33 quad_perm:[2,3,0,1] row_mask:0xf bank_mask:0xf
  s_nop 0
  v_add_f32_dpp v32, v32, v32 row_half_mirror row_mask:0xf bank_mask:0xf
  v_add_f32_dpp v33, v33, v33 row_half_mirror row_mask:0xf bank_mask:0xf
  s_nop 0
  v_add_f32_dpp v32, v32, v32 row_mirror row_mask:0xf bank_mask:0xf
  v_add_f32_dpp v33, v33, v33 row_mirror row_mask:0xf bank_mask:0xf
  v_mov_b32 v34, v32
  v_mov_b32 v35, v33
  s_nop 0
  v_permlane32_swap_b32 v32, v34
  v_permlane32_swap_b32 v33, v35
  v_add_f32 v32, v32, v34
  v_add_f32 v33, v33, v35
  v_mov_b32 v34, v32
  v_mov_b32 v35, v33
  s_nop 0
  v_permlane16_swap_b32 v32, v34
  v_permlane16_swap_b32 v33, v35
  v_add_f32 v32, v32, v34
  v_add_f32 v33, v33, v35
  v_mul_f32 v32, 0x3b124925, v32
  v_mul_f32 v33, 0x3b124925, v33
  v_fma_f32 v33, -v32, v32, v33
  v_max_f32 v33, 0, v33
  v_add_f32 v32, s60, v32
  v_cvt_pk_bf16_f32 v32, v32, v32
  v_lshlrev_b32 v32, 16, v32
  v_cvt_pk_bf16_f32 v33, v33, v33
  v_lshlrev_b32 v33, 16, v33
  v_add_f32 v33, 0x3727c5ac, v33
  v_cvt_pk_bf16_f32 v33, v33, v33
  v_lshlrev_b32 v33, 16, v33
  v_sqrt_f32 v33, v33
  s_nop 0
  v_cvt_pk_bf16_f32 v33, v33, v33
  v_lshlrev_b32 v33, 16, v33
  v_rcp_f32 v34, v33
  v_sub_f32 v35, v24, v32
  v_sub_f32 v36, v25, v32
  v_cvt_pk_bf16_f32 v37, v35, v36
  v_lshlrev_b32 v35, 16, v37
  v_and_b32 v36, 0xffff0000, v37
  v_mul_f32 v38, v35, v34
  v_mul_f32 v39, v36, v34
  v_fma_f32 v40, -v38, v33, v35
  v_fma_f32 v41, -v39, v33, v36
  v_fma_f32 v38, v40, v34, v38
  v_fma_f32 v39, v41, v34, v39
  v_cvt_pk_bf16_f32 v20, v38, v39
  v_cndmask_b32 v20, 0, v20, s[40:41]
  v_sub_f32 v35, v26, v32
  v_sub_f32 v36, v27, v32
  v_cvt_pk_bf16_f32 v37, v35, v36
  v_lshlrev_b32 v35, 16, v37
  v_and_b32 v36, 0xffff0000, v37
  v_mul_f32 v38, v35, v34
  v_mul_f32 v39, v36, v34
  v_fma_f32 v40, -v38, v33, v35
  v_fma_f32 v41, -v39, v33, v36
  v_fma_f32 v38, v40, v34, v38
  v_fma_f32 v39, v41, v34, v39
  v_cvt_pk_bf16_f32 v21, v38, v39
  v_cndmask_b32 v21, 0, v21, s[40:41]
  v_sub_f32 v35, v28, v32
  v_sub_f32 v36, v29, v32
  v_cvt_pk_bf16_f32 v37, v35, v36
  v_lshlrev_b32 v35, 16, v37
  v_and_b32 v36, 0xffff0000, v37
  v_mul_f32 v38, v35, v34
  v_mul_f32 v39, v36, v34
  v_fma_f32 v40, -v38, v33, v35
  v_fma_f32 v41, -v39, v33, v36
  v_fma_f32 v38, v40, v34, v38
  v_fma_f32 v39, v41, v34, v39
  v_cvt_pk_bf16_f32 v22, v38, v39
  v_cndmask_b32 v22, 0, v22, s[40:41]
  v_sub_f32 v35, v30, v32
  v_sub_f32 v36, v31, v32
  v_cvt_pk_bf16_f32 v37, v35, v36
  v_lshlrev_b32 v35, 16, v37
  v_and_b32 v36, 0xffff0000, v37
  v_mul_f32 v38, v35, v34
  v_mul_f32 v39, v36, v34
  v_fma_f32 v40, -v38, v33, v35
  v_fma_f32 v41, -v39, v33, v36
  v_fma_f32 v38, v40, v34, v38
  v_fma_f32 v39, v41, v34, v39
  v_cvt_pk_bf16_f32 v23, v38, v39
  v_cndmask_b32 v23, 0, v23, s[40:41]
  ds_write_b128 v9, v[20:23]
  s_waitcnt lgkmcnt(0)
  s_barrier
  ds_read_b128 v[12:15], v10
  s_waitcnt lgkmcnt(0)
  v_mfma_f32_16x16x32_bf16 v[64:67], v[12:15], v[128:131], 0
  v_mfma_f32_16x16x32_bf16 v[68:71], v[12:15], v[132:135], 0
  v_mfma_f32_16x16x32_bf16 v[72:75], v[12:15], v[136:139], 0
  v_mfma_f32_16x16x32_bf16 v[76:79], v[12:15], v[140:143], 0
  v_mfma_f32_16x16x32_bf16 v[80:83], v[12:15], v[144:147], 0
  v_mfma_f32_16x16x32_bf16 v[84:87], v[12:15], v[148:151], 0
  v_mfma_f32_16x16x32_bf16 v[88:91], v[12:15], v[152:155], 0
  v_mfma_f32_16x16x32_bf16 v[92:95], v[12:15], v[156:159], 0
  s_mov_b64 exec, s[50:51]
  s_nop 0
  ds_write_b128 v193, v[64:67] offset:4096
  ds_write_b128 v193, v[68:71] offset:4112
  ds_write_b128 v193, v[72:75] offset:4128
  ds_write_b128 v193, v[76:79] offset:4144
  ds_write_b128 v193, v[80:83] offset:4160
  ds_write_b128 v193, v[84:87] offset:4176
  ds_write_b128 v193, v[88:91] offset:4192
  s_nop 1
  ds_write_b128 v193, v[92:95] offset:4208
  s_mov_b64 exec, -1
  s_waitcnt lgkmcnt(0)
  s_barrier
  ds_read_b64 v[96:97], v194 offset:4096
  ds_read_b64 v[98:99], v194 offset:4608
  ds_read_b64 v[100:101], v194 offset:5120
  ds_read_b64 v[102:103], v194 offset:5632
  ds_read_b64 v[104:105], v194 offset:6144
  ds_read_b64 v[106:107], v194 offset:6656
  ds_read_b64 v[108:109], v194 offset:7168
  ds_read_b64 v[110:111], v194 offset:7680
  ds_read_b64 v[112:113], v194 offset:8192
  ds_read_b64 v[114:115], v194 offset:8704
  ds_read_b64 v[116:117], v194 offset:9216
  ds_read_b64 v[118:119], v194 offset:9728
  ds_read_b64 v[120:121], v194 offset:10240
  ds_read_b64 v[122:123], v194 offset:10752
  ds_read_b64 v[124:125], v194 offset:11264
  ds_read_b64 v[126:127], v194 offset:11776
  s_waitcnt lgkmcnt(8)
  v_pk_add_f32 v[96:97], v[96:97], v[98:99]
  v_pk_add_f32 v[100:101], v[100:101], v[102:103]
  v_pk_add_f32 v[104:105], v[104:105], v[106:107]
  v_pk_add_f32 v[108:109], v[108:109], v[110:111]
  v_pk_add_f32 v[96:97], v[96:97], v[100:101]
  v_pk_add_f32 v[104:105], v[104:105], v[108:109]
  v_pk_add_f32 v[96:97], v[96:97], v[104:105]
  s_waitcnt lgkmcnt(0)
  v_pk_add_f32 v[112:113], v[112:113], v[114:115]
  v_pk_add_f32 v[116:117], v[116:117], v[118:119]
  v_pk_add_f32 v[120:121], v[120:121], v[122:123]
  v_pk_add_f32 v[124:125], v[124:125], v[126:127]
  v_pk_add_f32 v[112:113], v[112:113], v[116:117]
  v_pk_add_f32 v[120:121], v[120:121], v[124:125]
  v_pk_add_f32 v[112:113], v[112:113], v[120:121]
  v_pk_add_f32 v[96:97], v[96:97], v[112:113]
  v_cvt_pk_bf16_f32 v32, v96, v97
  v_lshlrev_b32 v33, 16, v32
  v_and_b32 v34, 0xffff0000, v32
  v_mul_f32 v35, 0xbfb8aa3b, v33
  v_mul_f32 v36, 0xbfb8aa3b, v34
  v_exp_f32 v35, v35
  v_exp_f32 v36, v36
  s_nop 0
  v_add_f32 v35, 1.0, v35
  v_add_f32 v36, 1.0, v36
  v_rcp_f32 v35, v35
  v_rcp_f32 v36, v36
  s_nop 0
  v_mul_f32 v35, v33, v35
  v_mul_f32 v36, v34, v36
  v_cvt_pk_bf16_f32 v35, v35, v36
  ds_write_b16 v195, v35 offset:12288
  ds_write_b16_d16_hi v195, v35 offset:12352
  s_waitcnt lgkmcnt(0)
  ds_read_b128 v[12:15], v196 offset:12288
  s_waitcnt lgkmcnt(0)
  v_mfma_f32_16x16x32_bf16 v[64:67], v[12:15], v[160:163], 0
  v_mfma_f32_16x16x32_bf16 v[68:71], v[12:15], v[164:167], 0
  v_mfma_f32_16x16x32_bf16 v[72:75], v[12:15], v[168:171], 0
  v_mfma_f32_16x16x32_bf16 v[76:79], v[12:15], v[172:175], 0
  v_mfma_f32_16x16x32_bf16 v[80:83], v[12:15], v[176:179], 0
  v_mfma_f32_16x16x32_bf16 v[84:87], v[12:15], v[180:183], 0
  v_mfma_f32_16x16x32_bf16 v[88:91], v[12:15], v[184:187], 0
  v_mfma_f32_16x16x32_bf16 v[92:95], v[12:15], v[188:191], 0
  s_mov_b64 exec, 0xffff
  s_nop 0
  ds_write_b128 v197, v[64:67] offset:16384
  ds_write_b128 v197, v[68:71] offset:16400
  ds_write_b128 v197, v[72:75] offset:16416
  ds_write_b128 v197, v[76:79] offset:16432
  ds_write_b128 v197, v[80:83] offset:16448
  ds_write_b128 v197, v[84:87] offset:16464
  ds_write_b128 v197, v[88:91] offset:16480
  s_nop 1
  ds_write_b128 v197, v[92:95] offset:16496
  s_mov_b64 exec, -1
  s_waitcnt lgkmcnt(0)
  ds_read_b128 v[32:35], v198 offset:16384
  ds_read_b128 v[36:39], v198 offset:17408
  s_add_u32 s38, s44, 3584
  s_waitcnt lgkmcnt(1)
  buffer_atomic_add_f32 v32, v199, s[28:31], s44 offen offset:0
  buffer_atomic_add_f32 v33, v199, s[28:31], s44 offen offset:1792
  buffer_atomic_add_f32 v34, v199, s[28:31], s38 offen offset:0
  buffer_atomic_add_f32 v35, v199, s[28:31], s38 offen offset:1792
  s_cmp_eq_u32 s3, 3
  s_cbranch_scc1 C_sk2
  s_waitcnt lgkmcnt(0)
  buffer_atomic_add_f32 v36, v199, s[28:31], s44 offen offset:256
  buffer_atomic_add_f32 v37, v199, s[28:31], s44 offen offset:2048
  buffer_atomic_add_f32 v38, v199, s[28:31], s38 offen offset:256
  buffer_atomic_add_f32 v39, v199, s[28:31], s38 offen offset:2048
C_sk2:
  s_waitcnt vmcnt(0) lgkmcnt(0)
  s_barrier
  v_cmp_eq_u32 vcc, 0, v0
  s_and_saveexec_b64 s[48:49], vcc
  s_cbranch_execz C_nocnt
  v_mov_b32 v32, 1
  buffer_atomic_add v32, v45, s[56:59], 0 offen offset:64 sc0
  s_waitcnt vmcnt(0)
  ds_write_b32 v45, v32 offset:61440
  s_waitcnt lgkmcnt(0)
C_nocnt:
  s_mov_b64 exec, s[48:49]
  s_barrier
  ds_read_b32 v32, v45 offset:61440
  s_add_u32 s39, s39, 94208
  s_waitcnt lgkmcnt(0)
  v_readfirstlane_b32 s38, v32
  s_cmp_lg_u32 s38, 55
  s_cbranch_scc1 A_end
  buffer_load_dwordx4 v[64:67], v8, s[28:31], s39 offen sc1
  buffer_load_dwordx4 v[68:71], v8, s[28:31], s39 offen offset:16 sc1
  s_add_u32 s39, s39, 7168
  buffer_load_dwordx4 v[72:75], v8, s[28:31], s39 offen sc1
  buffer_load_dwordx4 v[76:79], v8, s[28:31], s39 offen offset:16 sc1
  s_add_u32 s39, s39, 7168
  buffer_load_dwordx4 v[80:83], v8, s[28:31], s39 offen sc1
  buffer_load_dwordx4 v[84:87], v8, s[28:31], s39 offen offset:16 sc1
  s_add_u32 s39, s39, 7168
  buffer_load_dwordx4 v[88:91], v8, s[28:31], s39 offen sc1
  buffer_load_dwordx4 v[92:95], v8, s[28:31], s39 offen offset:16 sc1
  s_add_u32 s39, s39, 7168
  s_mul_i32 s38, s3, 896
  s_waitcnt vmcnt(0)
  v_add_f32 v64, v64, v72
  v_add_f32 v80, v80, v88
  v_add_f32 v64, v64, v80
  v_add_f32 v65, v65, v73
  v_add_f32 v81, v81, v89
  v_add_f32 v65, v65, v81
  v_add_f32 v66, v66, v74
  v_add_f32 v82, v82, v90
  v_add_f32 v66, v66, v82
  v_add_f32 v67, v67, v75
  v_add_f32 v83, v83, v91
  v_add_f32 v67, v67, v83
  v_add_f32 v68, v68, v76
  v_add_f32 v84, v84, v92
  v_add_f32 v68, v68, v84
  v_add_f32 v69, v69, v77
  v_add_f32 v85, v85, v93
  v_add_f32 v69, v69, v85
  v_add_f32 v70, v70, v78
  v_add_f32 v86, v86, v94
  v_add_f32 v70, v70, v86
  v_add_f32 v71, v71, v79
  v_add_f32 v87, v87, v95
  v_add_f32 v71, v71, v87
  v_cvt_pk_bf16_f32 v32, v64, v65
  v_lshlrev_b32 v33, 16, v32
  v_and_b32 v34, 0xffff0000, v32
  v_add_f32 v33, v33, v24
  v_add_f32 v34, v34, v25
  v_cvt_pk_bf16_f32 v20, v33, v34
  v_cvt_pk_bf16_f32 v32, v66, v67
  v_lshlrev_b32 v33, 16, v32
  v_and_b32 v34, 0xffff0000, v32
  v_add_f32 v33, v33, v26
  v_add_f32 v34, v34, v27
  v_cvt_pk_bf16_f32 v21, v33, v34
  v_cvt_pk_bf16_f32 v32, v68, v69
  v_lshlrev_b32 v33, 16, v32
  v_and_b32 v34, 0xffff0000, v32
  v_add_f32 v33, v33, v28
  v_add_f32 v34, v34, v29
  v_cvt_pk_bf16_f32 v22, v33, v34
  v_cvt_pk_bf16_f32 v32, v70, v71
  v_lshlrev_b32 v33, 16, v32
  v_and_b32 v34, 0xffff0000, v32
  v_add_f32 v33, v33, v30
  v_add_f32 v34, v34, v31
  v_cvt_pk_bf16_f32 v23, v33, v34
  buffer_store_dwordx4 v[20:23], v7, s[52:55], s38 offen
A_end:
  s_endpgm
.section .rodata,"a"
.p2align 6
.amdhsa_kernel sequential_preLN__mha_block_cached__dense_activation_silu__decode_kernel
  .amdhsa_next_free_vgpr 496
  .amdhsa_next_free_sgpr 96
  .amdhsa_accum_offset 240
  .amdhsa_group_segment_fixed_size 0
  .amdhsa_kernarg_size 88
  .amdhsa_user_sgpr_count 2
  .amdhsa_user_sgpr_kernarg_segment_ptr 1
  .amdhsa_system_sgpr_workgroup_id_x 1
.end_amdhsa_kernel
```
